```python
import torch

def _softmax(x, axis=-1):
    return torch.softmax(x, dim=axis)

def _gelu(x):
    return torch.nn.functional.gelu(x, approximate='tanh')

def _silu(x):
    return torch.nn.functional.silu(x)

def _sigmoid(x):
    return torch.sigmoid(x)

def _layernorm(x, axis=-1, eps=1e-05):
    m = x.mean(dim=axis, keepdim=True)
    v = x.var(dim=axis, keepdim=True, unbiased=False)
    return (x - m) / torch.sqrt(v + eps)

def _scatter_add(tgt, idx, src, axis=0):
    return tgt.clone().index_add_(axis, idx, src)

def _segment_sum(src, seg, n):
    out = torch.zeros((n,) + src.shape[1:], dtype=src.dtype)
    return out.index_add_(0, seg, src)

def _pad(x, pw):
    flat = tuple((v for pair in reversed(pw) for v in pair))
    return torch.nn.functional.pad(x, flat)
kernel_name = 'parallel_sum__spectral_fnet__mixer_gmlp__prompt'

def setup_inputs():

    _w = lambda a: (lambda t: t.to(torch.bfloat16) if t.is_floating_point() else t)(torch.as_tensor(a))

    def _A_setup():
        B, S, D = (1, 2048, 512)
        ns = torch.arange(S)[:, None] * torch.arange(S)[None, :]
        nd = torch.arange(D)[:, None] * torch.arange(D)[None, :]
        Ws_re = torch.cos(-2.0 * torch.pi * ns / S).to(float)
        Ws_im = torch.sin(-2.0 * torch.pi * ns / S).to(float)
        Wd_re = torch.cos(-2.0 * torch.pi * nd / D).to(float)
        Wd_im = torch.sin(-2.0 * torch.pi * nd / D).to(float)
        return {'x': _w((lambda *s: torch.randn(*s, dtype=torch.bfloat16) * 0.05)(B, S, D)), 'dft_seq_re': _w(Ws_re), 'dft_seq_im': _w(Ws_im), 'dft_hid_re': _w(Wd_re), 'dft_hid_im': _w(Wd_im)}
    _A_in = _A_setup()

    def _B_setup():
        B, S, D, F = (1, 2048, 512, 1376)
        Fh = F // 2
        return {'x': _w((lambda *s: torch.randn(*s, dtype=torch.bfloat16) * 0.05)(B, S, D)), 'w_in': _w((lambda *s: torch.randn(*s, dtype=torch.bfloat16) * 1.6)(D, 2 * Fh)), 'w_sp': _w(0.01 * (lambda *s: torch.randn(*s, dtype=torch.bfloat16) * 1.6)(S, S)), 'b_sp': _w(1.0 + 0.01 * (lambda *s: torch.randn(*s, dtype=torch.bfloat16) * 0.8)(S)), 'w_out': _w((lambda *s: torch.randn(*s, dtype=torch.bfloat16) * 0.8)(Fh, D))}
    _B_in = _B_setup()
    return {'A_x': _A_in['x'], 'A_dft_seq_re': _A_in['dft_seq_re'], 'A_dft_seq_im': _A_in['dft_seq_im'], 'A_dft_hid_re': _A_in['dft_hid_re'], 'A_dft_hid_im': _A_in['dft_hid_im'], 'B_x': _B_in['x'], 'B_w_in': _B_in['w_in'], 'B_w_sp': _B_in['w_sp'], 'B_b_sp': _B_in['b_sp'], 'B_w_out': _B_in['w_out']}

def reference(A_x, A_dft_seq_re, A_dft_seq_im, A_dft_hid_re, A_dft_hid_im, B_x, B_w_in, B_w_sp, B_b_sp, B_w_out):

    def _A_ref(x, dft_seq_re, dft_seq_im, dft_hid_re, dft_hid_im):
        a = torch.einsum('bsd,ed->bse', x, dft_hid_re)
        b = torch.einsum('bsd,ed->bse', x, dft_hid_im)
        y = torch.einsum('ts,bse->bte', dft_seq_re, a) - torch.einsum('ts,bse->bte', dft_seq_im, b)
        return y

    def _B_ref(x, w_in, w_sp, b_sp, w_out):
        B, S, D = x.shape
        F = w_in.shape[-1]
        Fh = F // 2
        z = _gelu(torch.einsum('bsd,df->bsf', x, w_in))
        z1 = z[..., :Fh].clone()
        z2 = _layernorm(z[..., Fh:], axis=-1)
        g = torch.einsum('ts,bsf->btf', w_sp, z2) + b_sp[None, :, None]
        return torch.einsum('bsf,fd->bsd', z1 * g, w_out)
    x = A_x
    xn = _layernorm(x, axis=-1)
    return x + _A_ref(xn, A_dft_seq_re, A_dft_seq_im, A_dft_hid_re, A_dft_hid_im) + _B_ref(xn, B_w_in, B_w_sp, B_b_sp, B_w_out)
```

```asm
; @launch grid=(256,1,1) block=(256,1,1) lds=163840
.amdgcn_target "amdgcn-amd-amdhsa--gfx950"
.text
.globl parallel_sum__spectral_fnet__mixer_gmlp__prompt_kernel
.p2align 8
.type parallel_sum__spectral_fnet__mixer_gmlp__prompt_kernel,@function
parallel_sum__spectral_fnet__mixer_gmlp__prompt_kernel:
    s_cmp_ge_u32 s2, 256
    s_cbranch_scc1 L_end
    s_load_dwordx2 s[8:9], s[0:1], 0
    s_load_dwordx2 s[12:13], s[0:1], 48
    s_load_dwordx2 s[28:29], s[0:1], 96
    s_load_dwordx2 s[16:17], s[0:1], 56
    s_load_dwordx2 s[32:33], s[0:1], 64
    s_load_dwordx2 s[20:21], s[0:1], 72
    s_load_dwordx2 s[24:25], s[0:1], 80
    s_getpc_b64 s[6:7]
L_pc:
    s_lshr_b32 s50, s2, 3
    s_mul_i32 s50, s50, 1280
    v_lshrrev_b32 v12, 4, v0
    v_min_u32 v12, 9, v12
    v_lshl_add_u32 v12, v12, 7, s50
    v_min_u32 v12, L_end-L_pc, v12
    global_load_dword v13, v12, s[6:7]
    v_lshrrev_b32 v6, 6, v0
    v_and_b32 v1, 63, v0
    v_readfirstlane_b32 s38, v6
    s_and_b32 s47, s2, 7
    s_lshl_b32 s47, s47, 2
    s_lshr_b32 s47, 810960673, s47
    s_and_b32 s47, s47, 7
    s_xor_b32 s2, s2, s47
    s_bfe_u32 s47, s2, 0x20001
    s_lshl_b32 s47, s47, 3
    s_lshr_b32 s48, s2, 5
    s_add_u32 s36, s47, s48
    s_and_b32 s47, s2, 1
    s_lshl_b32 s47, s47, 2
    s_bfe_u32 s48, s2, 0x20003
    s_add_u32 s37, s47, s48
    v_and_b32 v2, 15, v0
    v_bfe_u32 v3, v0, 4, 2
    v_lshlrev_b32 v4, 4, v1
    s_lshr_b32 s39, s38, 1
    s_and_b32 s40, s38, 1
    s_mul_i32 s41, s37, 88
    s_cmp_eq_u32 s37, 7
    s_cselect_b32 s47, 8, 0
    s_sub_u32 s41, s41, s47
    s_cmp_lt_u32 s37, 6
    s_cselect_b32 s42, 11, 10
    s_mov_b32 s10, 2097152
    s_mov_b32 s11, 0x20000
    s_mov_b32 s14, 1409024
    s_mov_b32 s15, 0x20000
    s_mov_b32 s30, 11534336
    s_mov_b32 s31, 0x20000
    s_mov_b32 s18, 8388608
    s_mov_b32 s19, 0x20000
    s_mov_b32 s34, 4096
    s_mov_b32 s35, 0x20000
    s_mov_b32 s22, 704512
    s_mov_b32 s23, 0x20000
    s_mov_b32 s26, 2097152
    s_mov_b32 s27, 0x20000
    s_lshr_b32 s3, s36, 1
    s_mul_i32 s3, s3, 4
    s_mul_i32 s47, s2, 1
    s_add_u32 s3, s3, s47
    s_and_b32 s3, s3, 7
    s_lshl_b32 s47, s40, 10
    s_lshl_b32 s48, s39, 5
    s_add_u32 s55, s48, s36
    s_add_u32 s47, s47, s55
    s_lshl_b32 s49, s47, 10
    v_lshrrev_b32 v6, 3, v1
    v_and_b32 v7, 7, v1
    v_xor_b32 v7, v7, v3
    v_lshlrev_b32 v7, 4, v7
    v_lshl_add_u32 v7, v6, 16, v7
    v_add_u32 v5, s49, v7
    v_xor_b32 v14, 64, v5
    v_add_u32 v14, 523264, v14
    s_lshl_b32 s45, s38, 11
    s_add_u32 s45, s45, 73728
    s_mul_i32 s46, s38, 3072
    s_mul_i32 s47, s38, 44032
    s_lshl_b32 s48, s41, 1
    s_add_u32 s47, s47, s48
    s_add_u32 s47, s47, 1376
    s_lshl_b32 s4, s3, 7
    v_mov_b32 v10, 2146435072
    v_mul_u32_u24 v7, 171, v1
    v_lshrrev_b32 v7, 11, v7
    v_mad_i32_i24 v8, v7, -12, v1
    v_cmp_gt_u32 vcc, s42, v8
    v_mul_u32_u24 v7, 2752, v7
    v_lshl_add_u32 v7, v8, 4, v7
    v_add_u32 v7, s47, v7
    v_cndmask_b32 v15, v10, v7, vcc
    v_add_u32 v6, 64, v1
    v_mul_u32_u24 v7, 171, v6
    v_lshrrev_b32 v7, 11, v7
    v_mad_i32_i24 v8, v7, -12, v6
    v_lshrrev_b32 v9, 2, v7
    v_and_b32 v9, 2, v9
    v_xor_b32 v8, v8, v9
    v_cmp_gt_u32 vcc, s42, v8
    v_mul_u32_u24 v7, 2752, v7
    v_lshl_add_u32 v7, v8, 4, v7
    s_sub_u32 s47, s47, 1024
    v_add_u32 v7, s47, v7
    v_cndmask_b32 v16, v10, v7, vcc
    v_add_u32 v6, 128, v1
    v_mul_u32_u24 v7, 171, v6
    v_lshrrev_b32 v7, 11, v7
    v_mad_i32_i24 v8, v7, -12, v6
    v_xor_b32 v8, 2, v8
    v_cmp_gt_u32 vcc, s42, v8
    v_mul_u32_u24 v7, 2752, v7
    v_lshl_add_u32 v7, v8, 4, v7
    s_sub_u32 s47, s47, 1024
    v_add_u32 v7, s47, v7
    v_cndmask_b32 v17, v10, v7, vcc
    s_mov_b32 s93, 523200
    s_mov_b32 s94, 1046400
    s_mov_b32 s95, 1569600
    s_mov_b32 s96, 2097152
    s_mov_b32 s97, 2620352
    s_mov_b32 s98, 3143552
    s_mov_b32 s99, 3666752
    s_waitcnt lgkmcnt(0)
    s_lshl2_add_u32 s60, s37, s38
    s_lshl_b32 s60, s60, 6
    s_add_u32 s60, s60, s36
    s_add_u32 s61, s3, 4
    s_and_b32 s61, s61, 6
    s_lshl3_add_u32 s61, s60, s61
    s_lshl_b32 s61, s61, 7
    s_load_dword s56, s[8:9], s61 offset:0
    s_load_dword s56, s[8:9], s61 offset:64
    s_load_dword s56, s[8:9], s61 offset:128
    s_load_dword s56, s[8:9], s61 offset:192
    s_load_dword s56, s[8:9], s61 offset:32768
    s_load_dword s56, s[8:9], s61 offset:32832
    s_load_dword s56, s[8:9], s61 offset:32896
    s_load_dword s56, s[8:9], s61 offset:32960
    s_add_u32 s61, s3, 6
    s_and_b32 s61, s61, 6
    s_lshl3_add_u32 s61, s60, s61
    s_lshl_b32 s61, s61, 7
    s_load_dword s56, s[8:9], s61 offset:0
    s_load_dword s56, s[8:9], s61 offset:64
    s_load_dword s56, s[8:9], s61 offset:128
    s_load_dword s56, s[8:9], s61 offset:192
    s_load_dword s56, s[8:9], s61 offset:32768
    s_load_dword s56, s[8:9], s61 offset:32832
    s_load_dword s56, s[8:9], s61 offset:32896
    s_add_u32 m0, s45, 0
    s_nop 0
    buffer_load_dwordx4 v5, s[8:11], s4 offen  lds
    v_lshrrev_b32 v6, 1, v2
    buffer_load_dwordx4 v14, s[8:11], s4 offen offset:1024  lds
    v_xor_b32 v6, v6, v3
    v_lshlrev_b32 v6, 4, v6
    v_lshl_add_u32 v6, v2, 7, v6
    s_lshl_b32 s47, s39, 12
    s_add_u32 s47, s47, 73728
    s_xor_b32 s51, s39, s40
    s_lshl_b32 s48, s51, 6
    v_xad_u32 v20, v6, s48, 0
    v_add_u32 v20, s47, v20
    v_xor_b32 v21, 64, v20
    v_lshrrev_b32 v6, 2, v2
    v_lshl_add_u32 v6, v3, 3, v6
    v_mul_u32_u24 v6, 192, v6
    v_and_b32 v7, 1, v3
    v_xor_b32 v7, s40, v7
    s_add_u32 m0, s46, 0
    s_mul_i32 s5, s4, 1376
    buffer_load_dwordx4 v15, s[12:15], s5 offen  lds
    v_lshl_add_u32 v6, v7, 5, v6
    v_and_b32 v7, 3, v1
    v_lshl_add_u32 v6, v7, 3, v6
    s_mul_i32 s47, s51, 6144
    s_sub_u32 s48, 6144, s47
    v_add_u32 v22, s47, v6
    v_add_u32 v23, s48, v6
    v_and_b32 v6, 1, v1
    v_cmp_ne_u32 s[62:63], 0, v6
    v_and_b32 v6, 2, v1
    v_cmp_ne_u32 s[64:65], 0, v6
    s_mov_b32 s52, 2139193217
    v_accvgpr_write_b32 a188, s52
    v_accvgpr_write_b32 a189, s52
    v_accvgpr_write_b32 a190, s52
    v_accvgpr_write_b32 a191, s52
    buffer_load_dwordx4 v16, s[12:15], s5 offen offset:1024  lds
    s_mul_i32 s52, s36, 12
    s_add_u32 s52, s52, s38
    s_lshl3_add_u32 s52, s52, s37
    s_lshl_b32 s92, s52, 10
    v_mov_b32 v24, 0x3f803f80
    v_mov_b32 v25, 0x3f803f80
    v_mov_b32 v26, 0x3f803f80
    v_mov_b32 v27, 0x3f803f80
    s_and_b32 s47, s37, 1
    s_lshl_b32 s47, s47, 1
    s_add_u32 s44, s47, s40
    s_lshr_b32 s47, s37, 1
    s_lshl_b32 s47, s47, 6
    s_add_u32 s47, s47, s44
    v_lshl_add_u32 v6, v2, 2, s47
    v_subrev_u32 v6, 1, v6
    buffer_load_dwordx4 v17, s[12:15], s5 offen offset:2048  lds
    v_and_b32 v6, 0xff, v6
    v_add_u32 v6, 1, v6
    v_cvt_f32_u32 v6, v6
    v_mul_f32 v6, 0xbb000000, v6
    s_lshl_b32 s47, s3, 6
    v_lshl_add_u32 v7, v3, 3, s47
    v_cvt_f32_u32 v7, v7
    v_mul_f32 v7, v7, v6
    v_fract_f32 v7, v7
    s_mul_i32 s47, s51, 0x42000000
    v_fma_f32 v8, v6, s47, v7
    v_fma_f32 v9, -v6, s47, v7
    v_fmamk_f32 v68, v6, 0x42000000, v9
    v_mul_f32 v70, 0x42800000, v6
    v_sub_f32 v68, v68, v8
    v_sin_f32 v71, v70
    s_add_u32 m0, s45, 8192
    s_add_u32 s4, s4, 128
    s_and_b32 s4, s4, 0x380
    buffer_load_dwordx4 v5, s[8:11], s4 offen  lds
    v_cos_f32 v70, v70
    v_sin_f32 v69, v68
    v_cos_f32 v68, v68
    v_fmamk_f32 v28, v6, 0x00000000, v8
    v_add_f32 v29, v28, v6
    v_cos_f32 v30, v28
    v_cos_f32 v31, v29
    v_sin_f32 v32, v28
    v_sin_f32 v33, v29
    s_nop 0
    v_pk_mul_f32 v[44:45], v[32:33], v[68:69] op_sel:[0,1] op_sel_hi:[1,1]
    v_pk_mul_f32 v[46:47], v[30:31], v[68:69] op_sel:[0,1] op_sel_hi:[1,1]
    v_pk_fma_f32 v[44:45], v[30:31], v[68:69], v[44:45] op_sel_hi:[1,0,1] neg_lo:[0,0,1] neg_hi:[0,0,1]
    v_pk_fma_f32 v[46:47], v[32:33], v[68:69], v[46:47] op_sel_hi:[1,0,1]
    v_pk_mul_f32 v[48:49], v[32:33], v[70:71] op_sel:[0,1] op_sel_hi:[1,1]
    v_pk_mul_f32 v[50:51], v[30:31], v[70:71] op_sel:[0,1] op_sel_hi:[1,1]
    v_pk_fma_f32 v[48:49], v[30:31], v[70:71], v[48:49] op_sel_hi:[1,0,1] neg_lo:[0,0,1] neg_hi:[0,0,1]
    buffer_load_dwordx4 v14, s[8:11], s4 offen offset:1024  lds
    v_pk_fma_f32 v[50:51], v[32:33], v[70:71], v[50:51] op_sel_hi:[1,0,1]
    v_pk_mul_f32 v[52:53], v[46:47], v[70:71] op_sel:[0,1] op_sel_hi:[1,1]
    v_pk_mul_f32 v[54:55], v[44:45], v[70:71] op_sel:[0,1] op_sel_hi:[1,1]
    v_pk_fma_f32 v[52:53], v[44:45], v[70:71], v[52:53] op_sel_hi:[1,0,1] neg_lo:[0,0,1] neg_hi:[0,0,1]
    v_pk_fma_f32 v[54:55], v[46:47], v[70:71], v[54:55] op_sel_hi:[1,0,1]
    v_cvt_pk_bf16_f32 v30, v30, v31
    v_cvt_pk_bf16_f32 v32, v32, v33
    v_accvgpr_write_b32 a192, v30
    v_accvgpr_write_b32 a208, v32
    v_cvt_pk_bf16_f32 v44, v44, v45
    v_cvt_pk_bf16_f32 v46, v46, v47
    v_accvgpr_write_b32 a196, v44
    v_accvgpr_write_b32 a212, v46
    v_cvt_pk_bf16_f32 v48, v48, v49
    v_cvt_pk_bf16_f32 v50, v50, v51
    v_accvgpr_write_b32 a200, v48
    s_add_u32 m0, s46, 12288
    s_mul_i32 s5, s4, 1376
    buffer_load_dwordx4 v15, s[12:15], s5 offen  lds
    v_accvgpr_write_b32 a216, v50
    v_cvt_pk_bf16_f32 v52, v52, v53
    v_cvt_pk_bf16_f32 v54, v54, v55
    v_accvgpr_write_b32 a204, v52
    v_accvgpr_write_b32 a220, v54
    v_fmamk_f32 v36, v6, 0x40000000, v8
    v_add_f32 v37, v36, v6
    v_cos_f32 v38, v36
    v_cos_f32 v39, v37
    v_sin_f32 v40, v36
    v_sin_f32 v41, v37
    s_nop 0
    v_pk_mul_f32 v[56:57], v[40:41], v[68:69] op_sel:[0,1] op_sel_hi:[1,1]
    v_pk_mul_f32 v[58:59], v[38:39], v[68:69] op_sel:[0,1] op_sel_hi:[1,1]
    v_pk_fma_f32 v[56:57], v[38:39], v[68:69], v[56:57] op_sel_hi:[1,0,1] neg_lo:[0,0,1] neg_hi:[0,0,1]
    v_pk_fma_f32 v[58:59], v[40:41], v[68:69], v[58:59] op_sel_hi:[1,0,1]
    v_pk_mul_f32 v[60:61], v[40:41], v[70:71] op_sel:[0,1] op_sel_hi:[1,1]
    buffer_load_dwordx4 v16, s[12:15], s5 offen offset:1024  lds
    v_pk_mul_f32 v[62:63], v[38:39], v[70:71] op_sel:[0,1] op_sel_hi:[1,1]
    v_pk_fma_f32 v[60:61], v[38:39], v[70:71], v[60:61] op_sel_hi:[1,0,1] neg_lo:[0,0,1] neg_hi:[0,0,1]
    v_pk_fma_f32 v[62:63], v[40:41], v[70:71], v[62:63] op_sel_hi:[1,0,1]
    v_pk_mul_f32 v[64:65], v[58:59], v[70:71] op_sel:[0,1] op_sel_hi:[1,1]
    v_pk_mul_f32 v[66:67], v[56:57], v[70:71] op_sel:[0,1] op_sel_hi:[1,1]
    v_pk_fma_f32 v[64:65], v[56:57], v[70:71], v[64:65] op_sel_hi:[1,0,1] neg_lo:[0,0,1] neg_hi:[0,0,1]
    v_pk_fma_f32 v[66:67], v[58:59], v[70:71], v[66:67] op_sel_hi:[1,0,1]
    v_cvt_pk_bf16_f32 v38, v38, v39
    v_cvt_pk_bf16_f32 v40, v40, v41
    v_accvgpr_write_b32 a193, v38
    v_accvgpr_write_b32 a209, v40
    v_cvt_pk_bf16_f32 v56, v56, v57
    v_cvt_pk_bf16_f32 v58, v58, v59
    v_accvgpr_write_b32 a197, v56
    v_accvgpr_write_b32 a213, v58
    v_cvt_pk_bf16_f32 v60, v60, v61
    buffer_load_dwordx4 v17, s[12:15], s5 offen offset:2048  lds
    v_cvt_pk_bf16_f32 v62, v62, v63
    v_accvgpr_write_b32 a201, v60
    v_accvgpr_write_b32 a217, v62
    v_cvt_pk_bf16_f32 v64, v64, v65
    v_cvt_pk_bf16_f32 v66, v66, v67
    v_accvgpr_write_b32 a205, v64
    v_accvgpr_write_b32 a221, v66
    v_fmamk_f32 v28, v6, 0x40800000, v8
    v_add_f32 v29, v28, v6
    v_cos_f32 v30, v28
    v_cos_f32 v31, v29
    v_sin_f32 v32, v28
    v_sin_f32 v33, v29
    s_nop 0
    v_pk_mul_f32 v[44:45], v[32:33], v[68:69] op_sel:[0,1] op_sel_hi:[1,1]
    v_pk_mul_f32 v[46:47], v[30:31], v[68:69] op_sel:[0,1] op_sel_hi:[1,1]
    s_load_dword s56, s[8:9], s61 offset:32960
    s_lshl1_add_u32 s60, s2, s39
    s_mul_i32 s60, s60, 2752
    s_mul_i32 s61, s40, 704
    s_add_u32 s61, s61, s60
    s_load_dword s56, s[12:13], s61 offset:0
    s_load_dword s56, s[12:13], s61 offset:64
    s_load_dword s56, s[12:13], s61 offset:128
    s_load_dword s56, s[12:13], s61 offset:192
    s_load_dword s56, s[12:13], s61 offset:256
    s_load_dword s56, s[12:13], s61 offset:320
    s_load_dword s56, s[12:13], s61 offset:384
    s_load_dword s56, s[12:13], s61 offset:448
    s_load_dword s56, s[12:13], s61 offset:512
    s_load_dword s56, s[12:13], s61 offset:576
    s_load_dword s56, s[12:13], s61 offset:640
    v_pk_fma_f32 v[44:45], v[30:31], v[68:69], v[44:45] op_sel_hi:[1,0,1] neg_lo:[0,0,1] neg_hi:[0,0,1]
    v_pk_fma_f32 v[46:47], v[32:33], v[68:69], v[46:47] op_sel_hi:[1,0,1]
    v_pk_mul_f32 v[48:49], v[32:33], v[70:71] op_sel:[0,1] op_sel_hi:[1,1]
    v_pk_mul_f32 v[50:51], v[30:31], v[70:71] op_sel:[0,1] op_sel_hi:[1,1]
    v_pk_fma_f32 v[48:49], v[30:31], v[70:71], v[48:49] op_sel_hi:[1,0,1] neg_lo:[0,0,1] neg_hi:[0,0,1]
    v_pk_fma_f32 v[50:51], v[32:33], v[70:71], v[50:51] op_sel_hi:[1,0,1]
    v_pk_mul_f32 v[52:53], v[46:47], v[70:71] op_sel:[0,1] op_sel_hi:[1,1]
    v_pk_mul_f32 v[54:55], v[44:45], v[70:71] op_sel:[0,1] op_sel_hi:[1,1]
    v_pk_fma_f32 v[52:53], v[44:45], v[70:71], v[52:53] op_sel_hi:[1,0,1] neg_lo:[0,0,1] neg_hi:[0,0,1]
    v_pk_fma_f32 v[54:55], v[46:47], v[70:71], v[54:55] op_sel_hi:[1,0,1]
    v_cvt_pk_bf16_f32 v30, v30, v31
    v_cvt_pk_bf16_f32 v32, v32, v33
    v_accvgpr_write_b32 a194, v30
    v_accvgpr_write_b32 a210, v32
    v_cvt_pk_bf16_f32 v44, v44, v45
    v_cvt_pk_bf16_f32 v46, v46, v47
    s_add_u32 m0, s45, 16384
    s_add_u32 s4, s4, 128
    s_and_b32 s4, s4, 0x380
    buffer_load_dwordx4 v5, s[8:11], s4 offen  lds
    v_accvgpr_write_b32 a198, v44
    v_accvgpr_write_b32 a214, v46
    v_cvt_pk_bf16_f32 v48, v48, v49
    v_cvt_pk_bf16_f32 v50, v50, v51
    v_accvgpr_write_b32 a202, v48
    v_accvgpr_write_b32 a218, v50
    v_cvt_pk_bf16_f32 v52, v52, v53
    v_cvt_pk_bf16_f32 v54, v54, v55
    v_accvgpr_write_b32 a206, v52
    v_accvgpr_write_b32 a222, v54
    v_fmamk_f32 v36, v6, 0x40c00000, v8
    v_add_f32 v37, v36, v6
    v_cos_f32 v38, v36
    v_cos_f32 v39, v37
    v_sin_f32 v40, v36
    v_sin_f32 v41, v37
    buffer_load_dwordx4 v14, s[8:11], s4 offen offset:1024  lds
    v_pk_mul_f32 v[56:57], v[40:41], v[68:69] op_sel:[0,1] op_sel_hi:[1,1]
    v_pk_mul_f32 v[58:59], v[38:39], v[68:69] op_sel:[0,1] op_sel_hi:[1,1]
    v_pk_fma_f32 v[56:57], v[38:39], v[68:69], v[56:57] op_sel_hi:[1,0,1] neg_lo:[0,0,1] neg_hi:[0,0,1]
    v_pk_fma_f32 v[58:59], v[40:41], v[68:69], v[58:59] op_sel_hi:[1,0,1]
    v_pk_mul_f32 v[60:61], v[40:41], v[70:71] op_sel:[0,1] op_sel_hi:[1,1]
    v_pk_mul_f32 v[62:63], v[38:39], v[70:71] op_sel:[0,1] op_sel_hi:[1,1]
    v_pk_fma_f32 v[60:61], v[38:39], v[70:71], v[60:61] op_sel_hi:[1,0,1] neg_lo:[0,0,1] neg_hi:[0,0,1]
    v_pk_fma_f32 v[62:63], v[40:41], v[70:71], v[62:63] op_sel_hi:[1,0,1]
    v_pk_mul_f32 v[64:65], v[58:59], v[70:71] op_sel:[0,1] op_sel_hi:[1,1]
    v_pk_mul_f32 v[66:67], v[56:57], v[70:71] op_sel:[0,1] op_sel_hi:[1,1]
    v_pk_fma_f32 v[64:65], v[56:57], v[70:71], v[64:65] op_sel_hi:[1,0,1] neg_lo:[0,0,1] neg_hi:[0,0,1]
    v_pk_fma_f32 v[66:67], v[58:59], v[70:71], v[66:67] op_sel_hi:[1,0,1]
    v_cvt_pk_bf16_f32 v38, v38, v39
    v_cvt_pk_bf16_f32 v40, v40, v41
    v_accvgpr_write_b32 a195, v38
    v_accvgpr_write_b32 a211, v40
    s_add_u32 m0, s46, 24576
    s_mul_i32 s5, s4, 1376
    buffer_load_dwordx4 v15, s[12:15], s5 offen  lds
    v_cvt_pk_bf16_f32 v56, v56, v57
    v_cvt_pk_bf16_f32 v58, v58, v59
    v_accvgpr_write_b32 a199, v56
    v_accvgpr_write_b32 a215, v58
    v_cvt_pk_bf16_f32 v60, v60, v61
    v_cvt_pk_bf16_f32 v62, v62, v63
    v_accvgpr_write_b32 a203, v60
    v_accvgpr_write_b32 a219, v62
    v_cvt_pk_bf16_f32 v64, v64, v65
    v_cvt_pk_bf16_f32 v66, v66, v67
    v_accvgpr_write_b32 a207, v64
    v_accvgpr_write_b32 a223, v66
    v_cvt_f32_u32 v6, v2
    v_mul_f32 v6, 0x3d000000, v6
    v_lshlrev_b32 v7, 2, v3
    v_cvt_f32_u32 v7, v7
    buffer_load_dwordx4 v16, s[12:15], s5 offen offset:1024  lds
    v_mul_f32 v7, v7, v6
    v_bfe_i32 v8, v2, 0, 1
    v_and_b32 v8, 0x80008000, v8
    v_fmamk_f32 v28, v6, 0x00000000, v7
    v_add_f32 v29, v28, v6
    v_cos_f32 v30, v28
    v_cos_f32 v31, v29
    v_sin_f32 v32, v28
    v_sin_f32 v33, v29
    v_cvt_pk_bf16_f32 v30, v30, v31
    v_accvgpr_write_b32 a224, v30
    v_cvt_pk_bf16_f32 v32, v32, v33
    v_accvgpr_write_b32 a232, v32
    v_xor_b32 v30, 0x80000000, v30
    v_xor_b32 v32, 0x80000000, v32
    v_accvgpr_write_b32 a228, v30
    buffer_load_dwordx4 v17, s[12:15], s5 offen offset:2048  lds
    v_accvgpr_write_b32 a236, v32
    v_xor_b32 v30, v8, v30
    v_xor_b32 v32, v8, v32
    v_accvgpr_write_b32 a230, v30
    v_accvgpr_write_b32 a238, v32
    v_xor_b32 v30, 0x80000000, v30
    v_xor_b32 v32, 0x80000000, v32
    v_accvgpr_write_b32 a226, v30
    v_accvgpr_write_b32 a234, v32
    v_fmamk_f32 v36, v6, 0x40000000, v7
    v_add_f32 v37, v36, v6
    v_cos_f32 v38, v36
    v_cos_f32 v39, v37
    v_sin_f32 v40, v36
    v_sin_f32 v41, v37
    v_cvt_pk_bf16_f32 v38, v38, v39
    buffer_load_dword v18, off, s[28:31], 0 sc1
    v_accvgpr_write_b32 a225, v38
    v_cvt_pk_bf16_f32 v40, v40, v41
    v_accvgpr_write_b32 a233, v40
    v_xor_b32 v38, 0x80000000, v38
    v_xor_b32 v40, 0x80000000, v40
    v_accvgpr_write_b32 a229, v38
    v_accvgpr_write_b32 a237, v40
    v_xor_b32 v38, v8, v38
    v_xor_b32 v40, v8, v40
    v_accvgpr_write_b32 a231, v38
    v_accvgpr_write_b32 a239, v40
    v_xor_b32 v38, 0x80000000, v38
    v_xor_b32 v40, 0x80000000, v40
    v_accvgpr_write_b32 a227, v38
    v_accvgpr_write_b32 a235, v40
    s_cmp_eq_u32 s44, 0
    s_cselect_b32 s51, 1.0, -1.0
    s_waitcnt lgkmcnt(0)
    s_waitcnt vmcnt(11)
    s_barrier
    ds_read_b128 v[128:131], v20 offset:0
    ds_read_b128 v[132:135], v20 offset:2048
    ds_read_b64_tr_b16 v[56:57], v22 offset:0
    ds_read_b64_tr_b16 v[58:59], v22 offset:768
    ds_read_b64_tr_b16 v[60:61], v22 offset:64
    ds_read_b64_tr_b16 v[62:63], v22 offset:832
    ds_read_b64_tr_b16 v[64:65], v22 offset:128
    ds_read_b64_tr_b16 v[66:67], v22 offset:896
    s_waitcnt lgkmcnt(4)
    v_mfma_f32_16x16x32_bf16 v[80:83], v[56:59], v[128:131], 0
    ds_read_b128 v[136:139], v21 offset:0
    s_add_u32 m0, s45, 24576
    v_mfma_f32_16x16x32_bf16 v[84:87], v[56:59], v[132:135], 0
    ds_read_b128 v[140:143], v21 offset:2048
    s_add_u32 s4, s4, 128
    v_mfma_f32_16x16x32_bf16 v[28:31], v[56:59], v[24:27], 0
    ds_read_b64_tr_b16 v[68:69], v23 offset:0
    s_and_b32 s4, s4, 0x380
    s_waitcnt lgkmcnt(5)
    v_mfma_f32_16x16x32_bf16 v[88:91], v[60:63], v[128:131], 0
    ds_read_b64_tr_b16 v[70:71], v23 offset:768
    ds_read_b64_tr_b16 v[72:73], v23 offset:64
    v_mfma_f32_16x16x32_bf16 v[92:95], v[60:63], v[132:135], 0
    ds_read_b64_tr_b16 v[74:75], v23 offset:832
    ds_read_b64_tr_b16 v[76:77], v23 offset:128
    v_mfma_f32_16x16x32_bf16 v[32:35], v[60:63], v[24:27], 0
    ds_read_b64_tr_b16 v[78:79], v23 offset:896
    s_waitcnt lgkmcnt(8)
    v_mfma_f32_16x16x32_bf16 v[96:99], v[64:67], v[128:131], 0
    buffer_load_dwordx4 v5, s[8:11], s4 offen  lds
    v_mfma_f32_16x16x32_bf16 v[100:103], v[64:67], v[132:135], 0
    buffer_load_dwordx4 v14, s[8:11], s4 offen offset:1024  lds
    s_add_u32 m0, s46, 36864
    s_mul_i32 s5, s4, 1376
    buffer_load_dwordx4 v15, s[12:15], s5 offen  lds
    buffer_load_dwordx4 v16, s[12:15], s5 offen offset:1024  lds
    buffer_load_dwordx4 v17, s[12:15], s5 offen offset:2048  lds
    v_mfma_f32_16x16x32_bf16 v[36:39], v[64:67], v[24:27], 0
    s_waitcnt lgkmcnt(0)
    s_waitcnt vmcnt(11)
    s_barrier
    v_mfma_f32_16x16x32_bf16 v[48:51], v[136:139], v[136:139], 0
    ds_read_b128 v[144:147], v20 offset:8192
    s_add_u32 m0, s45, 32768
    v_mfma_f32_16x16x32_bf16 v[52:55], v[140:143], v[140:143], 0
    ds_read_b128 v[148:151], v20 offset:10240
    ds_read_b64_tr_b16 v[56:57], v22 offset:12288
    v_mfma_f32_16x16x32_bf16 v[40:43], v[24:27], v[136:139], 0
    ds_read_b64_tr_b16 v[58:59], v22 offset:13056
    s_add_u32 s4, s4, 128
    v_mfma_f32_16x16x32_bf16 v[44:47], v[24:27], v[140:143], 0
    ds_read_b64_tr_b16 v[60:61], v22 offset:12352
    s_and_b32 s4, s4, 0x380
    v_mfma_f32_16x16x32_bf16 v[80:83], v[68:71], v[136:139], v[80:83]
    buffer_load_dwordx4 v5, s[8:11], s4 offen  lds
    v_mfma_f32_16x16x32_bf16 v[84:87], v[68:71], v[140:143], v[84:87]
    ds_read_b64_tr_b16 v[62:63], v22 offset:13120
    ds_read_b64_tr_b16 v[64:65], v22 offset:12416
    v_mfma_f32_16x16x32_bf16 v[88:91], v[72:75], v[136:139], v[88:91]
    ds_read_b64_tr_b16 v[66:67], v22 offset:13184
    v_mfma_f32_16x16x32_bf16 v[92:95], v[72:75], v[140:143], v[92:95]
    buffer_load_dwordx4 v14, s[8:11], s4 offen offset:1024  lds
    v_mfma_f32_16x16x32_bf16 v[96:99], v[76:79], v[136:139], v[96:99]
    v_mfma_f32_16x16x32_bf16 v[100:103], v[76:79], v[140:143], v[100:103]
    s_add_u32 m0, s46, 49152
    s_waitcnt lgkmcnt(0)
    v_mfma_f32_16x16x32_bf16 v[80:83], v[56:59], v[144:147], v[80:83]
    ds_read_b128 v[152:155], v21 offset:8192
    s_mul_i32 s5, s4, 1376
    v_mfma_f32_16x16x32_bf16 v[84:87], v[56:59], v[148:151], v[84:87]
    buffer_load_dwordx4 v15, s[12:15], s5 offen  lds
    v_mfma_f32_16x16x32_bf16 v[28:31], v[56:59], v[24:27], v[28:31]
    ds_read_b128 v[156:159], v21 offset:10240
    ds_read_b64_tr_b16 v[68:69], v23 offset:12288
    v_mfma_f32_16x16x32_bf16 v[88:91], v[60:63], v[144:147], v[88:91]
    ds_read_b64_tr_b16 v[70:71], v23 offset:13056
    ds_read_b64_tr_b16 v[72:73], v23 offset:12352
    v_mfma_f32_16x16x32_bf16 v[92:95], v[60:63], v[148:151], v[92:95]
    ds_read_b64_tr_b16 v[74:75], v23 offset:13120
    ds_read_b64_tr_b16 v[76:77], v23 offset:12416
    v_mfma_f32_16x16x32_bf16 v[32:35], v[60:63], v[24:27], v[32:35]
    ds_read_b64_tr_b16 v[78:79], v23 offset:13184
    v_mfma_f32_16x16x32_bf16 v[96:99], v[64:67], v[144:147], v[96:99]
    buffer_load_dwordx4 v16, s[12:15], s5 offen offset:1024  lds
    v_mfma_f32_16x16x32_bf16 v[100:103], v[64:67], v[148:151], v[100:103]
    buffer_load_dwordx4 v17, s[12:15], s5 offen offset:2048  lds
    v_mfma_f32_16x16x32_bf16 v[36:39], v[64:67], v[24:27], v[36:39]
    s_waitcnt lgkmcnt(0)
    s_waitcnt vmcnt(11)
    s_barrier
    v_mfma_f32_16x16x32_bf16 v[48:51], v[152:155], v[152:155], v[48:51]
    ds_read_b128 v[160:163], v20 offset:16384
    s_add_u32 m0, s45, 40960
    v_mfma_f32_16x16x32_bf16 v[52:55], v[156:159], v[156:159], v[52:55]
    ds_read_b128 v[164:167], v20 offset:18432
    s_add_u32 s4, s4, 128
    v_mfma_f32_16x16x32_bf16 v[40:43], v[24:27], v[152:155], v[40:43]
    ds_read_b64_tr_b16 v[56:57], v22 offset:24576
    s_and_b32 s4, s4, 0x380
    v_mfma_f32_16x16x32_bf16 v[44:47], v[24:27], v[156:159], v[44:47]
    buffer_load_dwordx4 v5, s[8:11], s4 offen  lds
    v_mfma_f32_16x16x32_bf16 v[80:83], v[68:71], v[152:155], v[80:83]
    ds_read_b64_tr_b16 v[58:59], v22 offset:25344
    ds_read_b64_tr_b16 v[60:61], v22 offset:24640
    v_mfma_f32_16x16x32_bf16 v[84:87], v[68:71], v[156:159], v[84:87]
    ds_read_b64_tr_b16 v[62:63], v22 offset:25408
    ds_read_b64_tr_b16 v[64:65], v22 offset:24704
    v_mfma_f32_16x16x32_bf16 v[88:91], v[72:75], v[152:155], v[88:91]
    ds_read_b64_tr_b16 v[66:67], v22 offset:25472
    v_mfma_f32_16x16x32_bf16 v[92:95], v[72:75], v[156:159], v[92:95]
    buffer_load_dwordx4 v14, s[8:11], s4 offen offset:1024  lds
    v_mfma_f32_16x16x32_bf16 v[96:99], v[76:79], v[152:155], v[96:99]
    s_add_u32 m0, s46, 61440
    s_mul_i32 s5, s4, 1376
    v_mfma_f32_16x16x32_bf16 v[100:103], v[76:79], v[156:159], v[100:103]
    s_waitcnt lgkmcnt(0)
    v_mfma_f32_16x16x32_bf16 v[80:83], v[56:59], v[160:163], v[80:83]
    buffer_load_dwordx4 v15, s[12:15], s5 offen  lds
    v_mfma_f32_16x16x32_bf16 v[84:87], v[56:59], v[164:167], v[84:87]
    buffer_load_dwordx4 v16, s[12:15], s5 offen offset:1024  lds
    v_mfma_f32_16x16x32_bf16 v[28:31], v[56:59], v[24:27], v[28:31]
    ds_read_b128 v[168:171], v21 offset:16384
    ds_read_b128 v[172:175], v21 offset:18432
    v_mfma_f32_16x16x32_bf16 v[88:91], v[60:63], v[160:163], v[88:91]
    ds_read_b64_tr_b16 v[68:69], v23 offset:24576
    ds_read_b64_tr_b16 v[70:71], v23 offset:25344
    v_mfma_f32_16x16x32_bf16 v[92:95], v[60:63], v[164:167], v[92:95]
    ds_read_b64_tr_b16 v[72:73], v23 offset:24640
    ds_read_b64_tr_b16 v[74:75], v23 offset:25408
    v_mfma_f32_16x16x32_bf16 v[32:35], v[60:63], v[24:27], v[32:35]
    ds_read_b64_tr_b16 v[76:77], v23 offset:24704
    ds_read_b64_tr_b16 v[78:79], v23 offset:25472
    v_mfma_f32_16x16x32_bf16 v[96:99], v[64:67], v[160:163], v[96:99]
    buffer_load_dwordx4 v17, s[12:15], s5 offen offset:2048  lds
    v_mfma_f32_16x16x32_bf16 v[100:103], v[64:67], v[164:167], v[100:103]
    s_mul_i32 s48, s38, 768
    s_add_u32 s48, s48, 160768
    v_lshl_add_u32 v8, v1, 3, s48
    s_add_u32 s48, s48, 512
    v_lshl_add_u32 v9, v1, 2, s48
    s_xor_b32 s48, s38, 2
    s_mul_i32 s48, s48, 768
    s_add_u32 s48, s48, 161280
    v_lshl_add_u32 v11, v3, 6, s48
    s_mul_i32 s48, s39, 1536
    s_add_u32 s48, s48, 160768
    v_lshrrev_b32 v10, 2, v2
    v_lshl_add_u32 v10, v10, 4, v2
    v_lshl_add_u32 v10, v10, 3, s48
    v_mfma_f32_16x16x32_bf16 v[36:39], v[64:67], v[24:27], v[36:39]
    s_waitcnt lgkmcnt(0)
    s_waitcnt vmcnt(10)
    s_barrier
    v_mfma_f32_16x16x32_bf16 v[48:51], v[168:171], v[168:171], v[48:51]
    ds_read_b128 v[176:179], v20 offset:24576
    s_add_u32 m0, s45, 49152
    v_mfma_f32_16x16x32_bf16 v[52:55], v[172:175], v[172:175], v[52:55]
    ds_read_b128 v[180:183], v20 offset:26624
    s_add_u32 s4, s4, 128
    v_mfma_f32_16x16x32_bf16 v[40:43], v[24:27], v[168:171], v[40:43]
    ds_read_b64_tr_b16 v[56:57], v22 offset:36864
    s_and_b32 s4, s4, 0x380
    v_mfma_f32_16x16x32_bf16 v[44:47], v[24:27], v[172:175], v[44:47]
    buffer_load_dwordx4 v5, s[8:11], s4 offen  lds
    v_mfma_f32_16x16x32_bf16 v[80:83], v[68:71], v[168:171], v[80:83]
    ds_read_b64_tr_b16 v[58:59], v22 offset:37632
    ds_read_b64_tr_b16 v[60:61], v22 offset:36928
    v_mfma_f32_16x16x32_bf16 v[84:87], v[68:71], v[172:175], v[84:87]
    ds_read_b64_tr_b16 v[62:63], v22 offset:37696
    ds_read_b64_tr_b16 v[64:65], v22 offset:36992
    v_mfma_f32_16x16x32_bf16 v[88:91], v[72:75], v[168:171], v[88:91]
    ds_read_b64_tr_b16 v[66:67], v22 offset:37760
    v_mfma_f32_16x16x32_bf16 v[92:95], v[72:75], v[172:175], v[92:95]
    buffer_load_dwordx4 v14, s[8:11], s4 offen offset:1024  lds
    v_mfma_f32_16x16x32_bf16 v[96:99], v[76:79], v[168:171], v[96:99]
    s_add_u32 m0, s46, 0
    s_mul_i32 s5, s4, 1376
    v_mfma_f32_16x16x32_bf16 v[100:103], v[76:79], v[172:175], v[100:103]
    s_waitcnt lgkmcnt(0)
    v_mfma_f32_16x16x32_bf16 v[80:83], v[56:59], v[176:179], v[80:83]
    buffer_load_dwordx4 v15, s[12:15], s5 offen  lds
    v_mfma_f32_16x16x32_bf16 v[84:87], v[56:59], v[180:183], v[84:87]
    buffer_load_dwordx4 v16, s[12:15], s5 offen offset:1024  lds
    v_mfma_f32_16x16x32_bf16 v[28:31], v[56:59], v[24:27], v[28:31]
    ds_read_b128 v[184:187], v21 offset:24576
    ds_read_b128 v[188:191], v21 offset:26624
    v_mfma_f32_16x16x32_bf16 v[88:91], v[60:63], v[176:179], v[88:91]
    ds_read_b64_tr_b16 v[68:69], v23 offset:36864
    ds_read_b64_tr_b16 v[70:71], v23 offset:37632
    v_mfma_f32_16x16x32_bf16 v[92:95], v[60:63], v[180:183], v[92:95]
    ds_read_b64_tr_b16 v[72:73], v23 offset:36928
    ds_read_b64_tr_b16 v[74:75], v23 offset:37696
    v_mfma_f32_16x16x32_bf16 v[32:35], v[60:63], v[24:27], v[32:35]
    ds_read_b64_tr_b16 v[76:77], v23 offset:36992
    ds_read_b64_tr_b16 v[78:79], v23 offset:37760
    v_mfma_f32_16x16x32_bf16 v[96:99], v[64:67], v[176:179], v[96:99]
    buffer_load_dwordx4 v17, s[12:15], s5 offen offset:2048  lds
    v_mfma_f32_16x16x32_bf16 v[100:103], v[64:67], v[180:183], v[100:103]
    v_lshrrev_b32 v6, 1, v3
    v_lshrrev_b32 v7, 1, v2
    v_xor_b32 v6, v6, v7
    v_lshlrev_b32 v6, 4, v6
    v_lshl_add_u32 v6, v2, 7, v6
    v_and_b32 v7, 1, v3
    v_lshl_add_u32 v6, v7, 3, v6
    s_sub_u32 s47, s37, s3
    s_and_b32 s47, s47, 7
    s_lshl_b32 s47, s47, 13
    s_add_u32 s47, s47, s45
    v_add_u32 v6, s47, v6
    v_xor_b32 v7, 32, v6
    v_xor_b32 v12, 64, v6
    v_xor_b32 v13, 0x60, v6
    v_mfma_f32_16x16x32_bf16 v[36:39], v[64:67], v[24:27], v[36:39]
    s_waitcnt lgkmcnt(0)
    s_waitcnt vmcnt(10)
    s_barrier
    v_mfma_f32_16x16x32_bf16 v[48:51], v[184:187], v[184:187], v[48:51]
    ds_read_b128 v[192:195], v20 offset:32768
    s_add_u32 m0, s45, 57344
    v_mfma_f32_16x16x32_bf16 v[52:55], v[188:191], v[188:191], v[52:55]
    ds_read_b128 v[196:199], v20 offset:34816
    ds_read_b64_tr_b16 v[56:57], v22 offset:49152
    v_mfma_f32_16x16x32_bf16 v[40:43], v[24:27], v[184:187], v[40:43]
    ds_read_b64_tr_b16 v[58:59], v22 offset:49920
    s_add_u32 s4, s4, 128
    v_mfma_f32_16x16x32_bf16 v[44:47], v[24:27], v[188:191], v[44:47]
    ds_read_b64_tr_b16 v[60:61], v22 offset:49216
    s_and_b32 s4, s4, 0x380
    v_mfma_f32_16x16x32_bf16 v[80:83], v[68:71], v[184:187], v[80:83]
    buffer_load_dwordx4 v5, s[8:11], s4 offen  lds
    v_mfma_f32_16x16x32_bf16 v[84:87], v[68:71], v[188:191], v[84:87]
    ds_read_b64_tr_b16 v[62:63], v22 offset:49984
    ds_read_b64_tr_b16 v[64:65], v22 offset:49280
    v_mfma_f32_16x16x32_bf16 v[88:91], v[72:75], v[184:187], v[88:91]
    ds_read_b64_tr_b16 v[66:67], v22 offset:50048
    v_mfma_f32_16x16x32_bf16 v[92:95], v[72:75], v[188:191], v[92:95]
    buffer_load_dwordx4 v14, s[8:11], s4 offen offset:1024  lds
    v_mfma_f32_16x16x32_bf16 v[96:99], v[76:79], v[184:187], v[96:99]
    v_mfma_f32_16x16x32_bf16 v[100:103], v[76:79], v[188:191], v[100:103]
    s_add_u32 m0, s46, 12288
    s_waitcnt lgkmcnt(0)
    v_mfma_f32_16x16x32_bf16 v[80:83], v[56:59], v[192:195], v[80:83]
    ds_read_b128 v[200:203], v21 offset:32768
    s_mul_i32 s5, s4, 1376
    v_mfma_f32_16x16x32_bf16 v[84:87], v[56:59], v[196:199], v[84:87]
    buffer_load_dwordx4 v15, s[12:15], s5 offen  lds
    v_mfma_f32_16x16x32_bf16 v[28:31], v[56:59], v[24:27], v[28:31]
    ds_read_b128 v[204:207], v21 offset:34816
    ds_read_b64_tr_b16 v[68:69], v23 offset:49152
    v_mfma_f32_16x16x32_bf16 v[88:91], v[60:63], v[192:195], v[88:91]
    ds_read_b64_tr_b16 v[70:71], v23 offset:49920
    ds_read_b64_tr_b16 v[72:73], v23 offset:49216
    v_mfma_f32_16x16x32_bf16 v[92:95], v[60:63], v[196:199], v[92:95]
    ds_read_b64_tr_b16 v[74:75], v23 offset:49984
    ds_read_b64_tr_b16 v[76:77], v23 offset:49280
    v_mfma_f32_16x16x32_bf16 v[32:35], v[60:63], v[24:27], v[32:35]
    ds_read_b64_tr_b16 v[78:79], v23 offset:50048
    v_mfma_f32_16x16x32_bf16 v[96:99], v[64:67], v[192:195], v[96:99]
    buffer_load_dwordx4 v16, s[12:15], s5 offen offset:1024  lds
    v_mfma_f32_16x16x32_bf16 v[100:103], v[64:67], v[196:199], v[100:103]
    buffer_load_dwordx4 v17, s[12:15], s5 offen offset:2048  lds
    v_mfma_f32_16x16x32_bf16 v[36:39], v[64:67], v[24:27], v[36:39]
    s_waitcnt lgkmcnt(0)
    s_waitcnt vmcnt(10)
    s_barrier
    v_mfma_f32_16x16x32_bf16 v[48:51], v[200:203], v[200:203], v[48:51]
    ds_read_b128 v[208:211], v20 offset:40960
    v_subrev_u32 v15, 1376, v15
    v_mfma_f32_16x16x32_bf16 v[52:55], v[204:207], v[204:207], v[52:55]
    ds_read_b128 v[212:215], v20 offset:43008
    v_subrev_u32 v16, 1376, v16
    v_mfma_f32_16x16x32_bf16 v[40:43], v[24:27], v[200:203], v[40:43]
    ds_read_b64_tr_b16 v[56:57], v22 offset:61440
    v_subrev_u32 v17, 1376, v17
    v_mfma_f32_16x16x32_bf16 v[44:47], v[24:27], v[204:207], v[44:47]
    ds_read_b64_tr_b16 v[58:59], v22 offset:62208
    s_add_u32 s4, s4, 128
    v_mfma_f32_16x16x32_bf16 v[80:83], v[68:71], v[200:203], v[80:83]
    ds_read_b64_tr_b16 v[60:61], v22 offset:61504
    s_and_b32 s4, s4, 0x380
    v_mfma_f32_16x16x32_bf16 v[84:87], v[68:71], v[204:207], v[84:87]
    ds_read_b64_tr_b16 v[62:63], v22 offset:62272
    s_add_u32 m0, s46, 24576
    v_mfma_f32_16x16x32_bf16 v[88:91], v[72:75], v[200:203], v[88:91]
    ds_read_b64_tr_b16 v[64:65], v22 offset:61568
    ds_read_b64_tr_b16 v[66:67], v22 offset:62336
    v_mfma_f32_16x16x32_bf16 v[92:95], v[72:75], v[204:207], v[92:95]
    s_mul_i32 s5, s4, 1376
    v_mfma_f32_16x16x32_bf16 v[96:99], v[76:79], v[200:203], v[96:99]
    buffer_load_dwordx4 v15, s[12:15], s5 offen  lds
    v_mfma_f32_16x16x32_bf16 v[100:103], v[76:79], v[204:207], v[100:103]
    s_waitcnt lgkmcnt(0)
    v_mfma_f32_16x16x32_bf16 v[80:83], v[56:59], v[208:211], v[80:83]
    buffer_load_dwordx4 v16, s[12:15], s5 offen offset:1024  lds
    v_mfma_f32_16x16x32_bf16 v[84:87], v[56:59], v[212:215], v[84:87]
    buffer_load_dwordx4 v17, s[12:15], s5 offen offset:2048  lds
    v_mfma_f32_16x16x32_bf16 v[28:31], v[56:59], v[24:27], v[28:31]
    ds_read_b128 v[216:219], v21 offset:40960
    ds_read_b128 v[220:223], v21 offset:43008
    v_mfma_f32_16x16x32_bf16 v[88:91], v[60:63], v[208:211], v[88:91]
    ds_read_b64_tr_b16 v[68:69], v23 offset:61440
    ds_read_b64_tr_b16 v[70:71], v23 offset:62208
    v_mfma_f32_16x16x32_bf16 v[92:95], v[60:63], v[212:215], v[92:95]
    ds_read_b64_tr_b16 v[72:73], v23 offset:61504
    ds_read_b64_tr_b16 v[74:75], v23 offset:62272
    v_mfma_f32_16x16x32_bf16 v[32:35], v[60:63], v[24:27], v[32:35]
    ds_read_b64_tr_b16 v[76:77], v23 offset:61568
    ds_read_b64_tr_b16 v[78:79], v23 offset:62336
    v_mfma_f32_16x16x32_bf16 v[96:99], v[64:67], v[208:211], v[96:99]
    s_add_u32 s92, s92, 7340032
    v_mfma_f32_16x16x32_bf16 v[100:103], v[64:67], v[212:215], v[100:103]
    buffer_store_dwordx4 a[188:191], v4, s[28:31], s92 offen sc1
    s_lshl2_add_u32 s61, s2, s38
    s_mul_i32 s61, s61, 768
    v_min_u32 v19, 5, v1
    v_lshl_add_u32 v19, v19, 7, s61
    v_mfma_f32_16x16x32_bf16 v[36:39], v[64:67], v[24:27], v[36:39]
    s_waitcnt lgkmcnt(0)
    s_waitcnt vmcnt(9)
    s_barrier
    v_mfma_f32_16x16x32_bf16 v[48:51], v[216:219], v[216:219], v[48:51]
    ds_read_b128 v[224:227], v20 offset:49152
    s_add_u32 s4, s4, 128
    v_mfma_f32_16x16x32_bf16 v[52:55], v[220:223], v[220:223], v[52:55]
    ds_read_b128 v[228:231], v20 offset:51200
    ds_read_b64_tr_b16 v[56:57], v22 offset:0
    v_mfma_f32_16x16x32_bf16 v[40:43], v[24:27], v[216:219], v[40:43]
    ds_read_b64_tr_b16 v[58:59], v22 offset:768
    s_and_b32 s4, s4, 0x380
    v_mfma_f32_16x16x32_bf16 v[44:47], v[24:27], v[220:223], v[44:47]
    ds_read_b64_tr_b16 v[60:61], v22 offset:64
    s_add_u32 m0, s46, 36864
    v_mfma_f32_16x16x32_bf16 v[80:83], v[68:71], v[216:219], v[80:83]
    ds_read_b64_tr_b16 v[62:63], v22 offset:832
    ds_read_b64_tr_b16 v[64:65], v22 offset:128
    v_mfma_f32_16x16x32_bf16 v[84:87], v[68:71], v[220:223], v[84:87]
    ds_read_b64_tr_b16 v[66:67], v22 offset:896
    s_mul_i32 s5, s4, 1376
    v_mfma_f32_16x16x32_bf16 v[88:91], v[72:75], v[216:219], v[88:91]
    buffer_load_dwordx4 v15, s[12:15], s5 offen  lds
    v_mfma_f32_16x16x32_bf16 v[92:95], v[72:75], v[220:223], v[92:95]
    v_mfma_f32_16x16x32_bf16 v[96:99], v[76:79], v[216:219], v[96:99]
    v_mfma_f32_16x16x32_bf16 v[100:103], v[76:79], v[220:223], v[100:103]
    s_waitcnt lgkmcnt(0)
    v_mfma_f32_16x16x32_bf16 v[80:83], v[56:59], v[224:227], v[80:83]
    buffer_load_dwordx4 v16, s[12:15], s5 offen offset:1024  lds
    v_mfma_f32_16x16x32_bf16 v[84:87], v[56:59], v[228:231], v[84:87]
    ds_read_b128 v[232:235], v21 offset:49152
    ds_read_b128 v[236:239], v21 offset:51200
    v_mfma_f32_16x16x32_bf16 v[28:31], v[56:59], v[24:27], v[28:31]
    buffer_load_dwordx4 v17, s[12:15], s5 offen offset:2048  lds
    v_mfma_f32_16x16x32_bf16 v[88:91], v[60:63], v[224:227], v[88:91]
    ds_read_b64_tr_b16 v[68:69], v23 offset:0
    ds_read_b64_tr_b16 v[70:71], v23 offset:768
    v_mfma_f32_16x16x32_bf16 v[92:95], v[60:63], v[228:231], v[92:95]
    ds_read_b64_tr_b16 v[72:73], v23 offset:64
    ds_read_b64_tr_b16 v[74:75], v23 offset:832
    v_mfma_f32_16x16x32_bf16 v[32:35], v[60:63], v[24:27], v[32:35]
    ds_read_b64_tr_b16 v[76:77], v23 offset:128
    ds_read_b64_tr_b16 v[78:79], v23 offset:896
    v_mfma_f32_16x16x32_bf16 v[96:99], v[64:67], v[224:227], v[96:99]
    s_add_u32 s92, s92, 32768
    v_mfma_f32_16x16x32_bf16 v[100:103], v[64:67], v[228:231], v[100:103]
    buffer_store_dwordx4 a[188:191], v4, s[28:31], s92 offen sc1
    v_mfma_f32_16x16x32_bf16 v[36:39], v[64:67], v[24:27], v[36:39]
    s_waitcnt lgkmcnt(0)
    s_waitcnt vmcnt(8)
    s_barrier
    v_mfma_f32_16x16x32_bf16 v[48:51], v[232:235], v[232:235], v[48:51]
    ds_read_b128 v[240:243], v20 offset:57344
    s_add_u32 s4, s4, 128
    v_mfma_f32_16x16x32_bf16 v[52:55], v[236:239], v[236:239], v[52:55]
    ds_read_b128 v[244:247], v20 offset:59392
    ds_read_b64_tr_b16 v[56:57], v22 offset:12288
    v_mfma_f32_16x16x32_bf16 v[40:43], v[24:27], v[232:235], v[40:43]
    ds_read_b64_tr_b16 v[58:59], v22 offset:13056
    s_and_b32 s4, s4, 0x380
    v_mfma_f32_16x16x32_bf16 v[44:47], v[24:27], v[236:239], v[44:47]
    ds_read_b64_tr_b16 v[60:61], v22 offset:12352
    s_add_u32 m0, s46, 49152
    v_mfma_f32_16x16x32_bf16 v[80:83], v[68:71], v[232:235], v[80:83]
    ds_read_b64_tr_b16 v[62:63], v22 offset:13120
    s_mul_i32 s5, s4, 1376
    v_mfma_f32_16x16x32_bf16 v[84:87], v[68:71], v[236:239], v[84:87]
    ds_read_b64_tr_b16 v[64:65], v22 offset:12416
    ds_read_b64_tr_b16 v[66:67], v22 offset:13184
    v_mfma_f32_16x16x32_bf16 v[88:91], v[72:75], v[232:235], v[88:91]
    buffer_load_dwordx4 v15, s[12:15], s5 offen  lds
    v_mfma_f32_16x16x32_bf16 v[92:95], v[72:75], v[236:239], v[92:95]
    v_mfma_f32_16x16x32_bf16 v[96:99], v[76:79], v[232:235], v[96:99]
    buffer_load_dwordx4 v16, s[12:15], s5 offen offset:1024  lds
    v_mfma_f32_16x16x32_bf16 v[100:103], v[76:79], v[236:239], v[100:103]
    s_waitcnt lgkmcnt(0)
    v_mfma_f32_16x16x32_bf16 v[48:51], v[240:243], v[240:243], v[48:51]
    ds_read_b128 v[248:251], v21 offset:57344
    ds_read_b128 v[252:255], v21 offset:59392
    v_mfma_f32_16x16x32_bf16 v[52:55], v[244:247], v[244:247], v[52:55]
    buffer_load_dwordx4 v17, s[12:15], s5 offen offset:2048  lds
    v_mfma_f32_16x16x32_bf16 v[40:43], v[24:27], v[240:243], v[40:43]
    s_mov_b32 vcc_lo, 0x00f0000f
    s_mov_b32 vcc_hi, 0xf0000f00
    ds_read_b64_tr_b16 v[68:69], v23 offset:12288
    ds_read_b64_tr_b16 v[70:71], v23 offset:13056
    v_mfma_f32_16x16x32_bf16 v[44:47], v[24:27], v[244:247], v[44:47]
    v_cndmask_b32 v48, v48, v49, s[62:63]
    v_cndmask_b32 v49, v50, v51, s[62:63]
    ds_read_b64_tr_b16 v[72:73], v23 offset:12352
    s_add_u32 s92, s92, 32768
    v_mfma_f32_16x16x32_bf16 v[28:31], v[56:59], v[24:27], v[28:31]
    v_cndmask_b32 v48, v48, v49, s[64:65]
    v_cndmask_b32 v52, v52, v53, s[62:63]
    ds_read_b64_tr_b16 v[74:75], v23 offset:13120
    ds_read_b64_tr_b16 v[76:77], v23 offset:12416
    v_mfma_f32_16x16x32_bf16 v[32:35], v[60:63], v[24:27], v[32:35]
    v_cndmask_b32 v53, v54, v55, s[62:63]
    v_cndmask_b32 v52, v52, v53, s[64:65]
    buffer_store_dwordx4 a[188:191], v4, s[28:31], s92 offen sc1
    v_mfma_f32_16x16x32_bf16 v[36:39], v[64:67], v[24:27], v[36:39]
    v_cndmask_b32 v40, v40, v48, vcc
    ds_read_b64_tr_b16 v[78:79], v23 offset:13184
    v_mfma_f32_16x16x32_bf16 v[80:83], v[56:59], v[240:243], v[80:83]
    v_cndmask_b32 v41, v44, v52, vcc
    ds_write_b64 v8, v[40:41]
    ds_read_b64 v[104:105], v6
    v_mfma_f32_16x16x32_bf16 v[84:87], v[56:59], v[244:247], v[84:87]
    s_mov_b32 vcc_lo, 0xf0f0f0f0
    s_mov_b32 vcc_hi, 0xf0f0f0f0
    v_mfma_f32_16x16x32_bf16 v[88:91], v[60:63], v[240:243], v[88:91]
    v_cndmask_b32 v48, v28, v29, s[62:63]
    v_cndmask_b32 v49, v30, v31, s[62:63]
    ds_read_b64 v[106:107], v7
    v_mfma_f32_16x16x32_bf16 v[92:95], v[60:63], v[244:247], v[92:95]
    v_cndmask_b32 v48, v48, v49, s[64:65]
    v_cndmask_b32 v50, v32, v33, s[62:63]
    ds_read_b64 v[108:109], v12
    v_mfma_f32_16x16x32_bf16 v[96:99], v[64:67], v[240:243], v[96:99]
    v_cndmask_b32 v51, v34, v35, s[62:63]
    ds_read_b64 v[110:111], v13
    v_mfma_f32_16x16x32_bf16 v[100:103], v[64:67], v[244:247], v[100:103]
    v_cndmask_b32 v50, v50, v51, s[64:65]
    v_cndmask_b32 v48, v48, v50, vcc
    s_waitcnt lgkmcnt(5)
    v_mfma_f32_16x16x32_bf16 v[80:83], v[68:71], v[248:251], v[80:83]
    s_mov_b32 vcc_lo, 0xff00ff00
    s_mov_b32 vcc_hi, 0xff00ff00
    s_add_u32 s4, s4, 128
    v_mfma_f32_16x16x32_bf16 v[84:87], v[68:71], v[252:255], v[84:87]
    v_cndmask_b32 v50, v36, v37, s[62:63]
    v_cndmask_b32 v51, v38, v39, s[62:63]
    s_and_b32 s4, s4, 0x380
    v_mfma_f32_16x16x32_bf16 v[88:91], v[72:75], v[248:251], v[88:91]
    v_cndmask_b32 v50, v50, v51, s[64:65]
    v_cndmask_b32 v48, v48, v50, vcc
    s_add_u32 m0, s46, 61440
    s_mul_i32 s5, s4, 1376
    v_mfma_f32_16x16x32_bf16 v[92:95], v[72:75], v[252:255], v[92:95]
    ds_write_b32 v9, v48
    buffer_load_dwordx4 v15, s[12:15], s5 offen  lds
    v_mfma_f32_16x16x32_bf16 v[96:99], v[76:79], v[248:251], v[96:99]
    buffer_load_dwordx4 v16, s[12:15], s5 offen offset:1024  lds
    v_mfma_f32_16x16x32_bf16 v[100:103], v[76:79], v[252:255], v[100:103]
    buffer_load_dwordx4 v17, s[12:15], s5 offen offset:2048  lds
    s_waitcnt lgkmcnt(0)
    s_waitcnt vmcnt(11)
    s_barrier
    ds_read2_b64 v[48:51], v10 offset1:96
    v_xor_b32 v10, 128, v10
    ds_read2_b64 v[52:55], v10 offset1:96
    ds_read_b128 v[56:59], v11 offset:0
    ds_read_b128 v[60:63], v11 offset:16
    ds_read_b128 v[64:67], v11 offset:32
    v_readfirstlane_b32 s43, v18
    s_add_u32 s4, s4, 128
    s_and_b32 s4, s4, 0x380
    s_add_u32 m0, s46, 0
    s_mul_i32 s5, s4, 1376
    buffer_load_dwordx4 v15, s[12:15], s5 offen  lds
    v_xor_b32 v6, v2, v3
    v_lshlrev_b32 v6, 4, v6
    v_mul_u32_u24 v7, 9, v3
    v_and_b32 v7, 17, v7
    v_lshl_add_u32 v6, v7, 18, v6
    s_lshl_b32 s47, s55, 1
    s_add_u32 s47, s47, s40
    s_lshl_b32 s47, s47, 11
    v_add_u32 v5, s47, v6
    s_mul_i32 s53, s38, 21760
    s_add_u32 s53, s53, 73728
    v_bfe_u32 v6, v1, 1, 3
    v_mul_u32_u24 v6, 1088, v6
    v_lshrrev_b32 v7, 3, v1
    v_bfi_b32 v7, 1, v1, v7
    v_and_b32 v7, 3, v7
    v_lshl_add_u32 v6, v7, 8, v6
    v_lshl_add_u32 v6, v7, 4, v6
    v_lshrrev_b32 v7, 5, v1
    v_lshl_add_u32 v6, v7, 7, v6
    v_add_u32 v14, s53, v6
    v_xor_b32 v20, 16, v14
    buffer_load_dwordx4 v16, s[12:15], s5 offen offset:1024  lds
    v_xor_b32 v21, 32, v14
    v_xor_b32 v112, 48, v14
    s_lshl_b32 s45, s37, 2
    s_lshr_b32 s45, 286326784, s45
    s_and_b32 s45, s45, 7
    s_mul_i32 s47, s40, 2
    s_xor_b32 s45, s45, s47
    s_lshl_b32 s45, s45, 8
    v_add_u32 v5, s45, v5
    s_mul_i32 s43, s43, 1664525
    s_add_u32 s43, s43, 1013904223
    s_lshr_b32 s56, s43, 8
    s_lshr_b32 s57, s43, 16
    s_lshr_b32 s58, s43, 24
    s_movk_i32 s59, 0xff
    s_waitcnt lgkmcnt(3)
    v_pk_add_f32 v[52:53], v[52:53], v[54:55]
    v_pk_add_f32 v[48:49], v[48:49], v[50:51]
    v_mul_f32 v114, 0xbb000000, v52
    v_mul_f32 v8, v114, v114
    v_sub_f32 v8, 0x3727c5ac, v8
    v_mul_f32 v115, 0xbb000000, v53
    v_mul_f32 v9, v115, v115
    v_sub_f32 v9, 0x3727c5ac, v9
    buffer_load_dwordx4 v17, s[12:15], s5 offen offset:2048  lds
    v_fmamk_f32 v8, v48, 0x3b000000, v8
    v_max_f32 v8, 0x3727c5ac, v8
    v_fmamk_f32 v9, v49, 0x3b000000, v9
    v_max_f32 v9, 0x3727c5ac, v9
    v_rsq_f32 v122, v8
    v_rsq_f32 v123, v9
    v_sqrt_f32 v120, v8
    v_sqrt_f32 v121, v9
    s_waitcnt lgkmcnt(2)
    v_pk_add_f32 v[28:29], v[28:29], v[56:57]
    v_pk_add_f32 v[30:31], v[30:31], v[58:59]
    s_waitcnt lgkmcnt(1)
    v_pk_add_f32 v[32:33], v[32:33], v[60:61]
    v_pk_add_f32 v[34:35], v[34:35], v[62:63]
    s_waitcnt lgkmcnt(0)
    v_pk_add_f32 v[36:37], v[36:37], v[64:65]
    v_pk_add_f32 v[38:39], v[38:39], v[66:67]
    v_mul_f32 v118, 0xc0135761, v122
    v_mul_f32 v8, v122, v122
    v_mul_f32 v119, 0xc0135761, v123
    v_mul_f32 v9, v123, v123
    v_mul_f32 v8, 0x3d372713, v8
    v_mul_f32 v116, v118, v8
    v_mul_f32 v9, 0x3d372713, v9
    v_mul_f32 v117, v119, v9
    v_pk_fma_f32 v[80:81], v[114:115], v[28:29], v[80:81] op_sel:[0,0,0] op_sel_hi:[0,1,1]
    s_add_u32 m0, s53, 0
    s_nop 0
    buffer_load_dwordx4 v5, s[16:19], 0 offen offset:0  lds
    v_pk_fma_f32 v[82:83], v[114:115], v[30:31], v[82:83] op_sel:[0,0,0] op_sel_hi:[0,1,1]
    v_pk_fma_f32 v[84:85], v[114:115], v[28:29], v[84:85] op_sel:[1,0,0] op_sel_hi:[1,1,1]
    v_pk_fma_f32 v[86:87], v[114:115], v[30:31], v[86:87] op_sel:[1,0,0] op_sel_hi:[1,1,1]
    v_pk_mul_f32 v[56:57], v[80:81], v[80:81]
    v_pk_mul_f32 v[58:59], v[82:83], v[82:83]
    v_pk_mul_f32 v[60:61], v[84:85], v[84:85]
    v_pk_mul_f32 v[62:63], v[86:87], v[86:87]
    v_pk_fma_f32 v[56:57], v[56:57], v[116:117], v[118:119] op_sel:[0,0,0] op_sel_hi:[1,0,0]
    v_pk_fma_f32 v[58:59], v[58:59], v[116:117], v[118:119] op_sel:[0,0,0] op_sel_hi:[1,0,0]
    v_pk_fma_f32 v[60:61], v[60:61], v[116:117], v[118:119] op_sel:[0,1,1] op_sel_hi:[1,1,1]
    v_pk_fma_f32 v[62:63], v[62:63], v[116:117], v[118:119] op_sel:[0,1,1] op_sel_hi:[1,1,1]
    buffer_load_dwordx4 v5, s[16:19], s93 offen offset:1088  lds
    v_pk_mul_f32 v[56:57], v[56:57], v[80:81]
    v_pk_mul_f32 v[58:59], v[58:59], v[82:83]
    v_pk_mul_f32 v[60:61], v[60:61], v[84:85]
    v_pk_mul_f32 v[62:63], v[62:63], v[86:87]
    v_exp_f32 v56, v56
    v_exp_f32 v57, v57
    v_exp_f32 v58, v58
    v_exp_f32 v59, v59
    v_exp_f32 v60, v60
    v_exp_f32 v61, v61
    v_exp_f32 v62, v62
    v_exp_f32 v63, v63
    buffer_load_dwordx4 v5, s[16:19], s94 offen offset:2176  lds
    v_pk_fma_f32 v[56:57], v[56:57], v[120:121], v[120:121] op_sel:[0,0,0] op_sel_hi:[1,0,0]
    v_pk_fma_f32 v[58:59], v[58:59], v[120:121], v[120:121] op_sel:[0,0,0] op_sel_hi:[1,0,0]
    v_pk_fma_f32 v[60:61], v[60:61], v[120:121], v[120:121] op_sel:[0,1,1] op_sel_hi:[1,1,1]
    v_pk_fma_f32 v[62:63], v[62:63], v[120:121], v[120:121] op_sel:[0,1,1] op_sel_hi:[1,1,1]
    v_rcp_f32 v56, v56
    v_rcp_f32 v57, v57
    v_rcp_f32 v58, v58
    v_rcp_f32 v59, v59
    v_rcp_f32 v60, v60
    v_rcp_f32 v61, v61
    v_rcp_f32 v62, v62
    v_rcp_f32 v63, v63
    buffer_load_dwordx4 v5, s[16:19], s95 offen offset:3264  lds
    v_pk_mul_f32 v[80:81], v[80:81], v[56:57]
    v_pk_mul_f32 v[82:83], v[82:83], v[58:59]
    v_pk_mul_f32 v[84:85], v[84:85], v[60:61]
    v_pk_mul_f32 v[86:87], v[86:87], v[62:63]
    v_pk_add_f32 v[68:69], v[80:81], v[82:83]
    v_pk_mul_f32 v[72:73], v[80:81], v[80:81]
    v_pk_fma_f32 v[72:73], v[82:83], v[82:83], v[72:73]
    v_pk_add_f32 v[70:71], v[84:85], v[86:87]
    v_pk_mul_f32 v[74:75], v[84:85], v[84:85]
    v_pk_fma_f32 v[74:75], v[86:87], v[86:87], v[74:75]
    v_pk_fma_f32 v[88:89], v[114:115], v[32:33], v[88:89] op_sel:[0,0,0] op_sel_hi:[0,1,1]
    v_pk_fma_f32 v[90:91], v[114:115], v[34:35], v[90:91] op_sel:[0,0,0] op_sel_hi:[0,1,1]
    s_add_u32 m0, s53, 4352
    s_nop 0
    buffer_load_dwordx4 v5, s[16:19], s96 offen offset:0  lds
    v_pk_fma_f32 v[92:93], v[114:115], v[32:33], v[92:93] op_sel:[1,0,0] op_sel_hi:[1,1,1]
    v_pk_fma_f32 v[94:95], v[114:115], v[34:35], v[94:95] op_sel:[1,0,0] op_sel_hi:[1,1,1]
    v_pk_mul_f32 v[56:57], v[88:89], v[88:89]
    v_pk_mul_f32 v[58:59], v[90:91], v[90:91]
    v_pk_mul_f32 v[60:61], v[92:93], v[92:93]
    v_pk_mul_f32 v[62:63], v[94:95], v[94:95]
    v_pk_fma_f32 v[56:57], v[56:57], v[116:117], v[118:119] op_sel:[0,0,0] op_sel_hi:[1,0,0]
    v_pk_fma_f32 v[58:59], v[58:59], v[116:117], v[118:119] op_sel:[0,0,0] op_sel_hi:[1,0,0]
    v_pk_fma_f32 v[60:61], v[60:61], v[116:117], v[118:119] op_sel:[0,1,1] op_sel_hi:[1,1,1]
    v_pk_fma_f32 v[62:63], v[62:63], v[116:117], v[118:119] op_sel:[0,1,1] op_sel_hi:[1,1,1]
    v_pk_mul_f32 v[56:57], v[56:57], v[88:89]
    v_pk_mul_f32 v[58:59], v[58:59], v[90:91]
    buffer_load_dwordx4 v5, s[16:19], s97 offen offset:1088  lds
    v_pk_mul_f32 v[60:61], v[60:61], v[92:93]
    v_pk_mul_f32 v[62:63], v[62:63], v[94:95]
    v_exp_f32 v56, v56
    v_exp_f32 v57, v57
    v_exp_f32 v58, v58
    v_exp_f32 v59, v59
    v_exp_f32 v60, v60
    v_exp_f32 v61, v61
    v_exp_f32 v62, v62
    v_exp_f32 v63, v63
    v_pk_fma_f32 v[56:57], v[56:57], v[120:121], v[120:121] op_sel:[0,0,0] op_sel_hi:[1,0,0]
    v_pk_fma_f32 v[58:59], v[58:59], v[120:121], v[120:121] op_sel:[0,0,0] op_sel_hi:[1,0,0]
    buffer_load_dwordx4 v5, s[16:19], s98 offen offset:2176  lds
    v_pk_fma_f32 v[60:61], v[60:61], v[120:121], v[120:121] op_sel:[0,1,1] op_sel_hi:[1,1,1]
    v_pk_fma_f32 v[62:63], v[62:63], v[120:121], v[120:121] op_sel:[0,1,1] op_sel_hi:[1,1,1]
    v_rcp_f32 v56, v56
    v_rcp_f32 v57, v57
    v_rcp_f32 v58, v58
    v_rcp_f32 v59, v59
    v_rcp_f32 v60, v60
    v_rcp_f32 v61, v61
    v_rcp_f32 v62, v62
    v_rcp_f32 v63, v63
    v_pk_mul_f32 v[88:89], v[88:89], v[56:57]
    buffer_load_dwordx4 v5, s[16:19], s99 offen offset:3264  lds
    v_pk_mul_f32 v[90:91], v[90:91], v[58:59]
    v_pk_mul_f32 v[92:93], v[92:93], v[60:61]
    v_pk_mul_f32 v[94:95], v[94:95], v[62:63]
    v_pk_add_f32 v[68:69], v[68:69], v[88:89]
    v_pk_fma_f32 v[72:73], v[88:89], v[88:89], v[72:73]
    v_pk_add_f32 v[68:69], v[68:69], v[90:91]
    v_pk_fma_f32 v[72:73], v[90:91], v[90:91], v[72:73]
    v_pk_add_f32 v[70:71], v[70:71], v[92:93]
    v_pk_fma_f32 v[74:75], v[92:93], v[92:93], v[74:75]
    v_pk_add_f32 v[70:71], v[70:71], v[94:95]
    v_pk_fma_f32 v[74:75], v[94:95], v[94:95], v[74:75]
    v_pk_fma_f32 v[96:97], v[114:115], v[36:37], v[96:97] op_sel:[0,0,0] op_sel_hi:[0,1,1]
    v_xor_b32 v5, 1024, v5
    s_add_u32 m0, s53, 8704
    s_nop 0
    buffer_load_dwordx4 v5, s[16:19], 0 offen offset:0  lds
    v_pk_fma_f32 v[98:99], v[114:115], v[38:39], v[98:99] op_sel:[0,0,0] op_sel_hi:[0,1,1]
    v_pk_fma_f32 v[100:101], v[114:115], v[36:37], v[100:101] op_sel:[1,0,0] op_sel_hi:[1,1,1]
    v_pk_fma_f32 v[102:103], v[114:115], v[38:39], v[102:103] op_sel:[1,0,0] op_sel_hi:[1,1,1]
    v_pk_mul_f32 v[56:57], v[96:97], v[96:97]
    v_pk_mul_f32 v[58:59], v[98:99], v[98:99]
    v_pk_mul_f32 v[60:61], v[100:101], v[100:101]
    v_pk_mul_f32 v[62:63], v[102:103], v[102:103]
    v_pk_fma_f32 v[56:57], v[56:57], v[116:117], v[118:119] op_sel:[0,0,0] op_sel_hi:[1,0,0]
    v_pk_fma_f32 v[58:59], v[58:59], v[116:117], v[118:119] op_sel:[0,0,0] op_sel_hi:[1,0,0]
    v_pk_fma_f32 v[60:61], v[60:61], v[116:117], v[118:119] op_sel:[0,1,1] op_sel_hi:[1,1,1]
    v_pk_fma_f32 v[62:63], v[62:63], v[116:117], v[118:119] op_sel:[0,1,1] op_sel_hi:[1,1,1]
    v_pk_mul_f32 v[56:57], v[56:57], v[96:97]
    buffer_load_dwordx4 v5, s[16:19], s93 offen offset:1088  lds
    v_pk_mul_f32 v[58:59], v[58:59], v[98:99]
    v_pk_mul_f32 v[60:61], v[60:61], v[100:101]
    v_pk_mul_f32 v[62:63], v[62:63], v[102:103]
    v_exp_f32 v56, v56
    v_exp_f32 v57, v57
    v_exp_f32 v58, v58
    v_exp_f32 v59, v59
    v_exp_f32 v60, v60
    v_exp_f32 v61, v61
    v_exp_f32 v62, v62
    v_exp_f32 v63, v63
    v_pk_fma_f32 v[56:57], v[56:57], v[120:121], v[120:121] op_sel:[0,0,0] op_sel_hi:[1,0,0]
    buffer_load_dwordx4 v5, s[16:19], s94 offen offset:2176  lds
    v_pk_fma_f32 v[58:59], v[58:59], v[120:121], v[120:121] op_sel:[0,0,0] op_sel_hi:[1,0,0]
    v_pk_fma_f32 v[60:61], v[60:61], v[120:121], v[120:121] op_sel:[0,1,1] op_sel_hi:[1,1,1]
    v_pk_fma_f32 v[62:63], v[62:63], v[120:121], v[120:121] op_sel:[0,1,1] op_sel_hi:[1,1,1]
    v_rcp_f32 v56, v56
    v_rcp_f32 v57, v57
    v_rcp_f32 v58, v58
    v_rcp_f32 v59, v59
    v_rcp_f32 v60, v60
    v_rcp_f32 v61, v61
    v_rcp_f32 v62, v62
    v_rcp_f32 v63, v63
    v_pk_mul_f32 v[96:97], v[96:97], v[56:57]
    buffer_load_dwordx4 v5, s[16:19], s95 offen offset:3264  lds
    v_pk_mul_f32 v[98:99], v[98:99], v[58:59]
    v_pk_mul_f32 v[100:101], v[100:101], v[60:61]
    v_pk_mul_f32 v[102:103], v[102:103], v[62:63]
    v_pk_add_f32 v[68:69], v[68:69], v[96:97]
    v_pk_fma_f32 v[72:73], v[96:97], v[96:97], v[72:73]
    v_pk_add_f32 v[68:69], v[68:69], v[98:99]
    v_pk_fma_f32 v[72:73], v[98:99], v[98:99], v[72:73]
    v_pk_add_f32 v[70:71], v[70:71], v[100:101]
    v_pk_fma_f32 v[74:75], v[100:101], v[100:101], v[74:75]
    v_pk_add_f32 v[70:71], v[70:71], v[102:103]
    v_pk_fma_f32 v[74:75], v[102:103], v[102:103], v[74:75]
    v_add_f32 v6, v68, v69
    v_add_f32 v8, v70, v71
    v_add_f32 v7, v72, v73
    v_add_f32 v9, v74, v75
    v_lshlrev_b32 v10, 3, v3
    v_lshrrev_b32 v10, v10, s43
    v_permlane32_swap_b32 v6, v8
    v_permlane32_swap_b32 v7, v9
    v_add_f32 v6, v6, v8
    v_add_f32 v7, v7, v9
    v_lshlrev_b32 v11, 2, v3
    v_lshl_add_u32 v11, v2, 4, v11
    v_permlane16_swap_b32 v6, v7
    s_lshl_b32 s47, s36, 1
    s_add_u32 s47, s47, s39
    s_lshl_b32 s47, s47, 12
    s_add_u32 s49, s47, 262144
    s_lshl_b32 s47, s37, 1
    s_add_u32 s47, s47, s40
    s_lshl_b32 s47, s47, 8
    s_add_u32 s47, s47, s49
    v_add_f32 v6, v6, v7
    v_bfi_b32 v6, s59, v10, v6
    buffer_store_dword v6, v11, s[28:31], s47 offen sc1
    s_cmp_eq_u32 s44, 1
    s_cbranch_scc1 L_f1
    s_cmp_eq_u32 s44, 3
    s_cbranch_scc1 L_f3
    v_mfma_f32_16x16x32_bf16 v[28:31], v[128:131], a[192:195], 0
    v_lshlrev_b32 v6, 4, v3
    v_mfma_f32_16x16x32_bf16 v[32:35], v[132:135], a[192:195], 0
    ds_bpermute_b32 v60, v6, v122 offset:0
    v_mfma_f32_16x16x32_bf16 v[36:39], v[128:131], a[208:211], 0
    ds_bpermute_b32 v61, v6, v122 offset:4
    ds_bpermute_b32 v62, v6, v122 offset:8
    v_mfma_f32_16x16x32_bf16 v[40:43], v[132:135], a[208:211], 0
    ds_bpermute_b32 v63, v6, v122 offset:12
    ds_bpermute_b32 v64, v6, v123 offset:0
    v_mfma_f32_16x16x32_bf16 v[28:31], v[136:139], a[196:199], v[28:31]
    ds_bpermute_b32 v65, v6, v123 offset:4
    ds_bpermute_b32 v66, v6, v123 offset:8
    v_mfma_f32_16x16x32_bf16 v[32:35], v[140:143], a[196:199], v[32:35]
    ds_bpermute_b32 v67, v6, v123 offset:12
    v_mfma_f32_16x16x32_bf16 v[36:39], v[136:139], a[212:215], v[36:39]
    s_add_u32 m0, s53, 13056
    v_mfma_f32_16x16x32_bf16 v[40:43], v[140:143], a[212:215], v[40:43]
    buffer_load_dwordx4 v5, s[16:19], s96 offen offset:0  lds
    v_mfma_f32_16x16x32_bf16 v[28:31], v[144:147], a[200:203], v[28:31]
    v_permlane16_swap_b32 v80, v84
    v_mfma_f32_16x16x32_bf16 v[32:35], v[148:151], a[200:203], v[32:35]
    v_permlane16_swap_b32 v81, v85
    v_mfma_f32_16x16x32_bf16 v[36:39], v[144:147], a[216:219], v[36:39]
    buffer_load_dwordx4 v5, s[16:19], s97 offen offset:1088  lds
    v_mfma_f32_16x16x32_bf16 v[40:43], v[148:151], a[216:219], v[40:43]
    v_permlane16_swap_b32 v82, v86
    v_mfma_f32_16x16x32_bf16 v[28:31], v[152:155], a[204:207], v[28:31]
    v_permlane16_swap_b32 v83, v87
    v_mfma_f32_16x16x32_bf16 v[32:35], v[156:159], a[204:207], v[32:35]
    buffer_load_dwordx4 v5, s[16:19], s98 offen offset:2176  lds
    v_mfma_f32_16x16x32_bf16 v[36:39], v[152:155], a[220:223], v[36:39]
    v_permlane16_swap_b32 v88, v92
    v_mfma_f32_16x16x32_bf16 v[40:43], v[156:159], a[220:223], v[40:43]
    v_permlane16_swap_b32 v89, v93
    v_mfma_f32_16x16x32_bf16 v[44:47], v[160:163], a[192:195], 0
    v_permlane16_swap_b32 v90, v94
    v_mfma_f32_16x16x32_bf16 v[48:51], v[164:167], a[192:195], 0
    v_permlane16_swap_b32 v91, v95
    v_mfma_f32_16x16x32_bf16 v[52:55], v[160:163], a[208:211], 0
    buffer_load_dwordx4 v5, s[16:19], s99 offen offset:3264  lds
    v_mfma_f32_16x16x32_bf16 v[56:59], v[164:167], a[208:211], 0
    v_permlane16_swap_b32 v96, v100
    v_mfma_f32_16x16x32_bf16 v[44:47], v[168:171], a[196:199], v[44:47]
    v_mfma_f32_16x16x32_bf16 v[48:51], v[172:175], a[196:199], v[48:51]
    v_permlane16_swap_b32 v97, v101
    v_mfma_f32_16x16x32_bf16 v[52:55], v[168:171], a[212:215], v[52:55]
    v_xor_b32 v5, 1280, v5
    s_add_u32 m0, s53, 17408
    v_mfma_f32_16x16x32_bf16 v[56:59], v[172:175], a[212:215], v[56:59]
    buffer_load_dwordx4 v5, s[16:19], 0 offen offset:0  lds
    v_mfma_f32_16x16x32_bf16 v[44:47], v[176:179], a[200:203], v[44:47]
    v_permlane16_swap_b32 v98, v102
    v_mfma_f32_16x16x32_bf16 v[48:51], v[180:183], a[200:203], v[48:51]
    v_permlane16_swap_b32 v99, v103
    v_mfma_f32_16x16x32_bf16 v[52:55], v[176:179], a[216:219], v[52:55]
    buffer_load_dwordx4 v5, s[16:19], s93 offen offset:1088  lds
    v_mfma_f32_16x16x32_bf16 v[56:59], v[180:183], a[216:219], v[56:59]
    s_lshr_b32 s47, s44, 1
    v_mfma_f32_16x16x32_bf16 v[44:47], v[184:187], a[204:207], v[44:47]
    s_bfe_u32 s48, s36, 0x10002
    s_lshl_b32 s48, s48, 1
    v_mfma_f32_16x16x32_bf16 v[48:51], v[188:191], a[204:207], v[48:51]
    s_xor_b32 s47, s47, s48
    v_mfma_f32_16x16x32_bf16 v[52:55], v[184:187], a[220:223], v[52:55]
    v_xor_b32 v7, s47, v3
    v_lshlrev_b32 v7, 4, v7
    v_mfma_f32_16x16x32_bf16 v[56:59], v[188:191], a[220:223], v[56:59]
    v_mul_u32_u24 v8, 65792, v2
    v_mfma_f32_16x16x32_bf16 v[28:31], v[192:195], a[192:195], v[28:31]
    buffer_load_dwordx4 v5, s[16:19], s94 offen offset:2176  lds
    v_mfma_f32_16x16x32_bf16 v[32:35], v[196:199], a[192:195], v[32:35]
    s_lshr_b32 s47, s37, 1
    s_lshl_b32 s47, s47, 6
    v_mfma_f32_16x16x32_bf16 v[36:39], v[192:195], a[208:211], v[36:39]
    s_add_u32 s47, s47, s55
    s_lshl_b32 s47, s47, 2
    v_mfma_f32_16x16x32_bf16 v[40:43], v[196:199], a[208:211], v[40:43]
    s_add_u32 s47, s47, s44
    s_lshl_b32 s47, s47, 6
    v_mfma_f32_16x16x32_bf16 v[28:31], v[200:203], a[196:199], v[28:31]
    v_add3_u32 v113, v7, v8, s47
    v_mfma_f32_16x16x32_bf16 v[32:35], v[204:207], a[196:199], v[32:35]
    buffer_load_dwordx4 v5, s[16:19], s95 offen offset:3264  lds
    v_mfma_f32_16x16x32_bf16 v[36:39], v[200:203], a[212:215], v[36:39]
    v_lshrrev_b32 v7, 5, v1
    s_lshl_b32 s47, s40, 1
    v_mfma_f32_16x16x32_bf16 v[40:43], v[204:207], a[212:215], v[40:43]
    v_add_u32 v7, s47, v7
    s_add_u32 s4, s4, 128
    v_mfma_f32_16x16x32_bf16 v[28:31], v[208:211], a[200:203], v[28:31]
    s_and_b32 s4, s4, 0x380
    s_add_u32 m0, s46, 12288
    v_mfma_f32_16x16x32_bf16 v[32:35], v[212:215], a[200:203], v[32:35]
    s_mul_i32 s5, s4, 1376
    v_mfma_f32_16x16x32_bf16 v[36:39], v[208:211], a[216:219], v[36:39]
    buffer_load_dwordx4 v15, s[12:15], s5 offen  lds
    v_mfma_f32_16x16x32_bf16 v[40:43], v[212:215], a[216:219], v[40:43]
    s_bfe_u32 s47, s36, 0x10001
    v_lshl_add_u32 v8, v7, 1, s47
    v_mfma_f32_16x16x32_bf16 v[28:31], v[216:219], a[204:207], v[28:31]
    v_and_b32 v9, 7, v1
    v_xor_b32 v8, v8, v9
    v_mfma_f32_16x16x32_bf16 v[32:35], v[220:223], a[204:207], v[32:35]
    v_lshlrev_b32 v8, 4, v8
    v_mfma_f32_16x16x32_bf16 v[36:39], v[216:219], a[220:223], v[36:39]
    buffer_load_dwordx4 v16, s[12:15], s5 offen offset:1024  lds
    v_mfma_f32_16x16x32_bf16 v[40:43], v[220:223], a[220:223], v[40:43]
    v_lshl_add_u32 v8, v7, 10, v8
    v_bfe_u32 v9, v1, 3, 2
    v_mfma_f32_16x16x32_bf16 v[44:47], v[224:227], a[192:195], v[44:47]
    buffer_load_dwordx4 v17, s[12:15], s5 offen offset:2048  lds
    v_mfma_f32_16x16x32_bf16 v[48:51], v[228:231], a[192:195], v[48:51]
    v_mul_u32_u24 v9, 98304, v9
    s_mul_i32 s47, s37, 393216
    v_mfma_f32_16x16x32_bf16 v[52:55], v[224:227], a[208:211], v[52:55]
    s_lshl_b32 s48, s39, 14
    s_add_u32 s47, s47, s48
    v_mfma_f32_16x16x32_bf16 v[56:59], v[228:231], a[208:211], v[56:59]
    s_lshr_b32 s48, s36, 3
    s_lshl_b32 s48, s48, 12
    v_mfma_f32_16x16x32_bf16 v[44:47], v[232:235], a[196:199], v[44:47]
    s_add_u32 s47, s47, s48
    s_and_b32 s48, s36, 7
    v_mfma_f32_16x16x32_bf16 v[48:51], v[236:239], a[196:199], v[48:51]
    s_lshl_b32 s48, s48, 7
    v_mfma_f32_16x16x32_bf16 v[52:55], v[232:235], a[212:215], v[52:55]
    s_add_u32 s47, s47, s48
    v_add3_u32 v124, v8, v9, s47
    v_mfma_f32_16x16x32_bf16 v[56:59], v[236:239], a[212:215], v[56:59]
    buffer_load_dwordx4 a[240:243], v4, s[28:31], s49 offen offset:0 sc1
    v_mfma_f32_16x16x32_bf16 v[44:47], v[240:243], a[200:203], v[44:47]
    v_add_u32 v7, 8, v7
    v_cmp_gt_u32 s[60:61], s42, v7
    v_mfma_f32_16x16x32_bf16 v[48:51], v[244:247], a[200:203], v[48:51]
    v_mov_b32 v7, 2146435072
    v_mfma_f32_16x16x32_bf16 v[52:55], v[240:243], a[216:219], v[52:55]
    buffer_load_dwordx4 a[244:247], v4, s[28:31], s49 offen offset:1024 sc1
    v_mfma_f32_16x16x32_bf16 v[56:59], v[244:247], a[216:219], v[56:59]
    v_cndmask_b32 v125, v7, v124, s[60:61]
    v_mfma_f32_16x16x32_bf16 v[44:47], v[248:251], a[204:207], v[44:47]
    buffer_load_dwordx4 a[248:251], v4, s[28:31], s49 offen offset:2048 sc1
    v_mfma_f32_16x16x32_bf16 v[48:51], v[252:255], a[204:207], v[48:51]
    v_mov_b32 v10, s51
    buffer_load_dwordx4 a[252:255], v4, s[28:31], s49 offen offset:3072 sc1
    s_mov_b32 s52, 0
    v_mfma_f32_16x16x32_bf16 v[52:55], v[248:251], a[220:223], v[52:55]
    v_mfma_f32_16x16x32_bf16 v[56:59], v[252:255], a[220:223], v[56:59]
    s_nop 6
    s_branch L_fj
L_f1:
    v_mfma_f32_16x16x32_bf16 v[28:31], v[128:131], a[192:195], 0
    v_lshlrev_b32 v6, 4, v3
    v_mfma_f32_16x16x32_bf16 v[32:35], v[132:135], a[192:195], 0
    ds_bpermute_b32 v60, v6, v122 offset:0
    v_mfma_f32_16x16x32_bf16 v[36:39], v[128:131], a[208:211], 0
    ds_bpermute_b32 v61, v6, v122 offset:4
    ds_bpermute_b32 v62, v6, v122 offset:8
    v_mfma_f32_16x16x32_bf16 v[40:43], v[132:135], a[208:211], 0
    ds_bpermute_b32 v63, v6, v122 offset:12
    ds_bpermute_b32 v64, v6, v123 offset:0
    v_mfma_f32_16x16x32_bf16 v[28:31], v[136:139], a[196:199], v[28:31]
    ds_bpermute_b32 v65, v6, v123 offset:4
    ds_bpermute_b32 v66, v6, v123 offset:8
    v_mfma_f32_16x16x32_bf16 v[32:35], v[140:143], a[196:199], v[32:35]
    ds_bpermute_b32 v67, v6, v123 offset:12
    v_mfma_f32_16x16x32_bf16 v[36:39], v[136:139], a[212:215], v[36:39]
    s_add_u32 m0, s53, 13056
    v_mfma_f32_16x16x32_bf16 v[40:43], v[140:143], a[212:215], v[40:43]
    buffer_load_dwordx4 v5, s[16:19], s96 offen offset:0  lds
    v_mfma_f32_16x16x32_bf16 v[28:31], v[144:147], a[200:203], v[28:31]
    v_permlane16_swap_b32 v80, v84
    v_mfma_f32_16x16x32_bf16 v[32:35], v[148:151], a[200:203], v[32:35]
    v_permlane16_swap_b32 v81, v85
    v_mfma_f32_16x16x32_bf16 v[36:39], v[144:147], a[216:219], v[36:39]
    buffer_load_dwordx4 v5, s[16:19], s97 offen offset:1088  lds
    v_mfma_f32_16x16x32_bf16 v[40:43], v[148:151], a[216:219], v[40:43]
    v_permlane16_swap_b32 v82, v86
    v_mfma_f32_16x16x32_bf16 v[28:31], v[152:155], a[204:207], v[28:31]
    v_permlane16_swap_b32 v83, v87
    v_mfma_f32_16x16x32_bf16 v[32:35], v[156:159], a[204:207], v[32:35]
    buffer_load_dwordx4 v5, s[16:19], s98 offen offset:2176  lds
    v_mfma_f32_16x16x32_bf16 v[36:39], v[152:155], a[220:223], v[36:39]
    v_permlane16_swap_b32 v88, v92
    v_mfma_f32_16x16x32_bf16 v[40:43], v[156:159], a[220:223], v[40:43]
    v_permlane16_swap_b32 v89, v93
    v_mfma_f32_16x16x32_bf16 v[52:55], v[160:163], a[192:195], 0
    v_permlane16_swap_b32 v90, v94
    v_mfma_f32_16x16x32_bf16 v[56:59], v[164:167], a[192:195], 0
    v_permlane16_swap_b32 v91, v95
    v_mfma_f32_16x16x32_bf16 v[28:31], v[160:163], a[208:211], v[28:31]
    buffer_load_dwordx4 v5, s[16:19], s99 offen offset:3264  lds
    v_mfma_f32_16x16x32_bf16 v[32:35], v[164:167], a[208:211], v[32:35]
    v_permlane16_swap_b32 v96, v100
    v_mfma_f32_16x16x32_bf16 v[52:55], v[168:171], a[196:199], v[52:55]
    v_mfma_f32_16x16x32_bf16 v[56:59], v[172:175], a[196:199], v[56:59]
    v_permlane16_swap_b32 v97, v101
    v_mfma_f32_16x16x32_bf16 v[28:31], v[168:171], a[212:215], v[28:31]
    v_xor_b32 v5, 1280, v5
    s_add_u32 m0, s53, 17408
    v_mfma_f32_16x16x32_bf16 v[32:35], v[172:175], a[212:215], v[32:35]
    buffer_load_dwordx4 v5, s[16:19], 0 offen offset:0  lds
    v_mfma_f32_16x16x32_bf16 v[52:55], v[176:179], a[200:203], v[52:55]
    v_permlane16_swap_b32 v98, v102
    v_mfma_f32_16x16x32_bf16 v[56:59], v[180:183], a[200:203], v[56:59]
    v_permlane16_swap_b32 v99, v103
    v_mfma_f32_16x16x32_bf16 v[28:31], v[176:179], a[216:219], v[28:31]
    buffer_load_dwordx4 v5, s[16:19], s93 offen offset:1088  lds
    v_mfma_f32_16x16x32_bf16 v[32:35], v[180:183], a[216:219], v[32:35]
    s_lshr_b32 s47, s44, 1
    v_mfma_f32_16x16x32_bf16 v[52:55], v[184:187], a[204:207], v[52:55]
    s_bfe_u32 s48, s36, 0x10002
    s_lshl_b32 s48, s48, 1
    v_mfma_f32_16x16x32_bf16 v[56:59], v[188:191], a[204:207], v[56:59]
    s_xor_b32 s47, s47, s48
    v_mfma_f32_16x16x32_bf16 v[28:31], v[184:187], a[220:223], v[28:31]
    v_xor_b32 v7, s47, v3
    v_lshlrev_b32 v7, 4, v7
    v_mfma_f32_16x16x32_bf16 v[32:35], v[188:191], a[220:223], v[32:35]
    v_mul_u32_u24 v8, 65792, v2
    v_mfma_f32_16x16x32_bf16 v[44:47], v[192:195], a[192:195], 0
    buffer_load_dwordx4 v5, s[16:19], s94 offen offset:2176  lds
    v_mfma_f32_16x16x32_bf16 v[48:51], v[196:199], a[192:195], 0
    s_lshr_b32 s47, s37, 1
    s_lshl_b32 s47, s47, 6
    v_mfma_f32_16x16x32_bf16 v[52:55], v[192:195], a[208:211], v[52:55]
    s_add_u32 s47, s47, s55
    s_lshl_b32 s47, s47, 2
    v_mfma_f32_16x16x32_bf16 v[56:59], v[196:199], a[208:211], v[56:59]
    s_add_u32 s47, s47, s44
    s_lshl_b32 s47, s47, 6
    v_mfma_f32_16x16x32_bf16 v[44:47], v[200:203], a[196:199], v[44:47]
    v_add3_u32 v113, v7, v8, s47
    v_mfma_f32_16x16x32_bf16 v[48:51], v[204:207], a[196:199], v[48:51]
    buffer_load_dwordx4 v5, s[16:19], s95 offen offset:3264  lds
    v_mfma_f32_16x16x32_bf16 v[52:55], v[200:203], a[212:215], v[52:55]
    v_lshrrev_b32 v7, 5, v1
    s_lshl_b32 s47, s40, 1
    v_mfma_f32_16x16x32_bf16 v[56:59], v[204:207], a[212:215], v[56:59]
    v_add_u32 v7, s47, v7
    s_add_u32 s4, s4, 128
    v_mfma_f32_16x16x32_bf16 v[44:47], v[208:211], a[200:203], v[44:47]
    s_and_b32 s4, s4, 0x380
    s_add_u32 m0, s46, 12288
    v_mfma_f32_16x16x32_bf16 v[48:51], v[212:215], a[200:203], v[48:51]
    s_mul_i32 s5, s4, 1376
    v_mfma_f32_16x16x32_bf16 v[52:55], v[208:211], a[216:219], v[52:55]
    buffer_load_dwordx4 v15, s[12:15], s5 offen  lds
    v_mfma_f32_16x16x32_bf16 v[56:59], v[212:215], a[216:219], v[56:59]
    s_bfe_u32 s47, s36, 0x10001
    v_lshl_add_u32 v8, v7, 1, s47
    v_mfma_f32_16x16x32_bf16 v[44:47], v[216:219], a[204:207], v[44:47]
    v_and_b32 v9, 7, v1
    v_xor_b32 v8, v8, v9
    v_mfma_f32_16x16x32_bf16 v[48:51], v[220:223], a[204:207], v[48:51]
    v_lshlrev_b32 v8, 4, v8
    v_mfma_f32_16x16x32_bf16 v[52:55], v[216:219], a[220:223], v[52:55]
    buffer_load_dwordx4 v16, s[12:15], s5 offen offset:1024  lds
    v_mfma_f32_16x16x32_bf16 v[56:59], v[220:223], a[220:223], v[56:59]
    v_lshl_add_u32 v8, v7, 10, v8
    v_bfe_u32 v9, v1, 3, 2
    v_mfma_f32_16x16x32_bf16 v[36:39], v[224:227], a[192:195], v[36:39]
    buffer_load_dwordx4 v17, s[12:15], s5 offen offset:2048  lds
    v_mfma_f32_16x16x32_bf16 v[40:43], v[228:231], a[192:195], v[40:43]
    v_mul_u32_u24 v9, 98304, v9
    s_mul_i32 s47, s37, 393216
    v_mfma_f32_16x16x32_bf16 v[44:47], v[224:227], a[208:211], v[44:47]
    s_lshl_b32 s48, s39, 14
    s_add_u32 s47, s47, s48
    v_mfma_f32_16x16x32_bf16 v[48:51], v[228:231], a[208:211], v[48:51]
    s_lshr_b32 s48, s36, 3
    s_lshl_b32 s48, s48, 12
    v_mfma_f32_16x16x32_bf16 v[36:39], v[232:235], a[196:199], v[36:39]
    s_add_u32 s47, s47, s48
    s_and_b32 s48, s36, 7
    v_mfma_f32_16x16x32_bf16 v[40:43], v[236:239], a[196:199], v[40:43]
    s_lshl_b32 s48, s48, 7
    v_mfma_f32_16x16x32_bf16 v[44:47], v[232:235], a[212:215], v[44:47]
    s_add_u32 s47, s47, s48
    v_add3_u32 v124, v8, v9, s47
    v_mfma_f32_16x16x32_bf16 v[48:51], v[236:239], a[212:215], v[48:51]
    buffer_load_dwordx4 a[240:243], v4, s[28:31], s49 offen offset:0 sc1
    v_mfma_f32_16x16x32_bf16 v[36:39], v[240:243], a[200:203], v[36:39]
    v_add_u32 v7, 8, v7
    v_cmp_gt_u32 s[60:61], s42, v7
    v_mfma_f32_16x16x32_bf16 v[40:43], v[244:247], a[200:203], v[40:43]
    v_mov_b32 v7, 2146435072
    v_mfma_f32_16x16x32_bf16 v[44:47], v[240:243], a[216:219], v[44:47]
    buffer_load_dwordx4 a[244:247], v4, s[28:31], s49 offen offset:1024 sc1
    v_mfma_f32_16x16x32_bf16 v[48:51], v[244:247], a[216:219], v[48:51]
    v_cndmask_b32 v125, v7, v124, s[60:61]
    v_mfma_f32_16x16x32_bf16 v[36:39], v[248:251], a[204:207], v[36:39]
    buffer_load_dwordx4 a[248:251], v4, s[28:31], s49 offen offset:2048 sc1
    v_mfma_f32_16x16x32_bf16 v[40:43], v[252:255], a[204:207], v[40:43]
    v_mov_b32 v10, s51
    buffer_load_dwordx4 a[252:255], v4, s[28:31], s49 offen offset:3072 sc1
    s_mov_b32 s52, 0
    v_mfma_f32_16x16x32_bf16 v[44:47], v[248:251], a[220:223], v[44:47]
    v_mfma_f32_16x16x32_bf16 v[48:51], v[252:255], a[220:223], v[48:51]
    s_nop 6
    s_branch L_fj
L_f3:
    v_mfma_f32_16x16x32_bf16 v[28:31], v[128:131], a[192:195], 0
    v_lshlrev_b32 v6, 4, v3
    v_mfma_f32_16x16x32_bf16 v[32:35], v[132:135], a[192:195], 0
    ds_bpermute_b32 v60, v6, v122 offset:0
    v_mfma_f32_16x16x32_bf16 v[36:39], v[128:131], a[208:211], 0
    ds_bpermute_b32 v61, v6, v122 offset:4
    ds_bpermute_b32 v62, v6, v122 offset:8
    v_mfma_f32_16x16x32_bf16 v[40:43], v[132:135], a[208:211], 0
    ds_bpermute_b32 v63, v6, v122 offset:12
    ds_bpermute_b32 v64, v6, v123 offset:0
    v_mfma_f32_16x16x32_bf16 v[28:31], v[136:139], a[196:199], v[28:31]
    ds_bpermute_b32 v65, v6, v123 offset:4
    ds_bpermute_b32 v66, v6, v123 offset:8
    v_mfma_f32_16x16x32_bf16 v[32:35], v[140:143], a[196:199], v[32:35]
    ds_bpermute_b32 v67, v6, v123 offset:12
    v_mfma_f32_16x16x32_bf16 v[36:39], v[136:139], a[212:215], v[36:39]
    s_add_u32 m0, s53, 13056
    v_mfma_f32_16x16x32_bf16 v[40:43], v[140:143], a[212:215], v[40:43]
    buffer_load_dwordx4 v5, s[16:19], s96 offen offset:0  lds
    v_mfma_f32_16x16x32_bf16 v[28:31], v[144:147], a[200:203], v[28:31]
    v_permlane16_swap_b32 v80, v84
    v_mfma_f32_16x16x32_bf16 v[32:35], v[148:151], a[200:203], v[32:35]
    v_permlane16_swap_b32 v81, v85
    v_mfma_f32_16x16x32_bf16 v[36:39], v[144:147], a[216:219], v[36:39]
    buffer_load_dwordx4 v5, s[16:19], s97 offen offset:1088  lds
    v_mfma_f32_16x16x32_bf16 v[40:43], v[148:151], a[216:219], v[40:43]
    v_permlane16_swap_b32 v82, v86
    v_mfma_f32_16x16x32_bf16 v[28:31], v[152:155], a[204:207], v[28:31]
    v_permlane16_swap_b32 v83, v87
    v_mfma_f32_16x16x32_bf16 v[32:35], v[156:159], a[204:207], v[32:35]
    buffer_load_dwordx4 v5, s[16:19], s98 offen offset:2176  lds
    v_mfma_f32_16x16x32_bf16 v[36:39], v[152:155], a[220:223], v[36:39]
    v_permlane16_swap_b32 v88, v92
    v_mfma_f32_16x16x32_bf16 v[40:43], v[156:159], a[220:223], v[40:43]
    v_permlane16_swap_b32 v89, v93
    v_mfma_f32_16x16x32_bf16 v[36:39], v[160:163], a[192:195], v[36:39]
    v_permlane16_swap_b32 v90, v94
    v_mfma_f32_16x16x32_bf16 v[40:43], v[164:167], a[192:195], v[40:43]
    v_permlane16_swap_b32 v91, v95
    v_mfma_f32_16x16x32_bf16 v[44:47], v[160:163], a[208:211], 0
    buffer_load_dwordx4 v5, s[16:19], s99 offen offset:3264  lds
    v_mfma_f32_16x16x32_bf16 v[48:51], v[164:167], a[208:211], 0
    v_permlane16_swap_b32 v96, v100
    v_mfma_f32_16x16x32_bf16 v[36:39], v[168:171], a[196:199], v[36:39]
    v_mfma_f32_16x16x32_bf16 v[40:43], v[172:175], a[196:199], v[40:43]
    v_permlane16_swap_b32 v97, v101
    v_mfma_f32_16x16x32_bf16 v[44:47], v[168:171], a[212:215], v[44:47]
    v_xor_b32 v5, 1280, v5
    s_add_u32 m0, s53, 17408
    v_mfma_f32_16x16x32_bf16 v[48:51], v[172:175], a[212:215], v[48:51]
    buffer_load_dwordx4 v5, s[16:19], 0 offen offset:0  lds
    v_mfma_f32_16x16x32_bf16 v[36:39], v[176:179], a[200:203], v[36:39]
    v_permlane16_swap_b32 v98, v102
    v_mfma_f32_16x16x32_bf16 v[40:43], v[180:183], a[200:203], v[40:43]
    v_permlane16_swap_b32 v99, v103
    v_mfma_f32_16x16x32_bf16 v[44:47], v[176:179], a[216:219], v[44:47]
    buffer_load_dwordx4 v5, s[16:19], s93 offen offset:1088  lds
    v_mfma_f32_16x16x32_bf16 v[48:51], v[180:183], a[216:219], v[48:51]
    s_lshr_b32 s47, s44, 1
    v_mfma_f32_16x16x32_bf16 v[36:39], v[184:187], a[204:207], v[36:39]
    s_bfe_u32 s48, s36, 0x10002
    s_lshl_b32 s48, s48, 1
    v_mfma_f32_16x16x32_bf16 v[40:43], v[188:191], a[204:207], v[40:43]
    s_xor_b32 s47, s47, s48
    v_mfma_f32_16x16x32_bf16 v[44:47], v[184:187], a[220:223], v[44:47]
    v_xor_b32 v7, s47, v3
    v_lshlrev_b32 v7, 4, v7
    v_mfma_f32_16x16x32_bf16 v[48:51], v[188:191], a[220:223], v[48:51]
    v_mul_u32_u24 v8, 65792, v2
    v_mfma_f32_16x16x32_bf16 v[44:47], v[192:195], a[192:195], v[44:47]
    buffer_load_dwordx4 v5, s[16:19], s94 offen offset:2176  lds
    v_mfma_f32_16x16x32_bf16 v[48:51], v[196:199], a[192:195], v[48:51]
    s_lshr_b32 s47, s37, 1
    s_lshl_b32 s47, s47, 6
    v_mfma_f32_16x16x32_bf16 v[52:55], v[192:195], a[208:211], 0
    s_add_u32 s47, s47, s55
    s_lshl_b32 s47, s47, 2
    v_mfma_f32_16x16x32_bf16 v[56:59], v[196:199], a[208:211], 0
    s_add_u32 s47, s47, s44
    s_lshl_b32 s47, s47, 6
    v_mfma_f32_16x16x32_bf16 v[44:47], v[200:203], a[196:199], v[44:47]
    v_add3_u32 v113, v7, v8, s47
    v_mfma_f32_16x16x32_bf16 v[48:51], v[204:207], a[196:199], v[48:51]
    buffer_load_dwordx4 v5, s[16:19], s95 offen offset:3264  lds
    v_mfma_f32_16x16x32_bf16 v[52:55], v[200:203], a[212:215], v[52:55]
    v_lshrrev_b32 v7, 5, v1
    s_lshl_b32 s47, s40, 1
    v_mfma_f32_16x16x32_bf16 v[56:59], v[204:207], a[212:215], v[56:59]
    v_add_u32 v7, s47, v7
    s_add_u32 s4, s4, 128
    v_mfma_f32_16x16x32_bf16 v[44:47], v[208:211], a[200:203], v[44:47]
    s_and_b32 s4, s4, 0x380
    s_add_u32 m0, s46, 12288
    v_mfma_f32_16x16x32_bf16 v[48:51], v[212:215], a[200:203], v[48:51]
    s_mul_i32 s5, s4, 1376
    v_mfma_f32_16x16x32_bf16 v[52:55], v[208:211], a[216:219], v[52:55]
    buffer_load_dwordx4 v15, s[12:15], s5 offen  lds
    v_mfma_f32_16x16x32_bf16 v[56:59], v[212:215], a[216:219], v[56:59]
    s_bfe_u32 s47, s36, 0x10001
    v_lshl_add_u32 v8, v7, 1, s47
    v_mfma_f32_16x16x32_bf16 v[44:47], v[216:219], a[204:207], v[44:47]
    v_and_b32 v9, 7, v1
    v_xor_b32 v8, v8, v9
    v_mfma_f32_16x16x32_bf16 v[48:51], v[220:223], a[204:207], v[48:51]
    v_lshlrev_b32 v8, 4, v8
    v_mfma_f32_16x16x32_bf16 v[52:55], v[216:219], a[220:223], v[52:55]
    buffer_load_dwordx4 v16, s[12:15], s5 offen offset:1024  lds
    v_mfma_f32_16x16x32_bf16 v[56:59], v[220:223], a[220:223], v[56:59]
    v_lshl_add_u32 v8, v7, 10, v8
    v_bfe_u32 v9, v1, 3, 2
    v_mfma_f32_16x16x32_bf16 v[52:55], v[224:227], a[192:195], v[52:55]
    buffer_load_dwordx4 v17, s[12:15], s5 offen offset:2048  lds
    v_mfma_f32_16x16x32_bf16 v[56:59], v[228:231], a[192:195], v[56:59]
    v_mul_u32_u24 v9, 98304, v9
    s_mul_i32 s47, s37, 393216
    v_mfma_f32_16x16x32_bf16 v[28:31], v[224:227], a[208:211], v[28:31]
    s_lshl_b32 s48, s39, 14
    s_add_u32 s47, s47, s48
    v_mfma_f32_16x16x32_bf16 v[32:35], v[228:231], a[208:211], v[32:35]
    s_lshr_b32 s48, s36, 3
    s_lshl_b32 s48, s48, 12
    v_mfma_f32_16x16x32_bf16 v[52:55], v[232:235], a[196:199], v[52:55]
    s_add_u32 s47, s47, s48
    s_and_b32 s48, s36, 7
    v_mfma_f32_16x16x32_bf16 v[56:59], v[236:239], a[196:199], v[56:59]
    s_lshl_b32 s48, s48, 7
    v_mfma_f32_16x16x32_bf16 v[28:31], v[232:235], a[212:215], v[28:31]
    s_add_u32 s47, s47, s48
    v_add3_u32 v124, v8, v9, s47
    v_mfma_f32_16x16x32_bf16 v[32:35], v[236:239], a[212:215], v[32:35]
    buffer_load_dwordx4 a[240:243], v4, s[28:31], s49 offen offset:0 sc1
    v_mfma_f32_16x16x32_bf16 v[52:55], v[240:243], a[200:203], v[52:55]
    v_add_u32 v7, 8, v7
    v_cmp_gt_u32 s[60:61], s42, v7
    v_mfma_f32_16x16x32_bf16 v[56:59], v[244:247], a[200:203], v[56:59]
    v_mov_b32 v7, 2146435072
    v_mfma_f32_16x16x32_bf16 v[28:31], v[240:243], a[216:219], v[28:31]
    buffer_load_dwordx4 a[244:247], v4, s[28:31], s49 offen offset:1024 sc1
    v_mfma_f32_16x16x32_bf16 v[32:35], v[244:247], a[216:219], v[32:35]
    v_cndmask_b32 v125, v7, v124, s[60:61]
    v_mfma_f32_16x16x32_bf16 v[52:55], v[248:251], a[204:207], v[52:55]
    buffer_load_dwordx4 a[248:251], v4, s[28:31], s49 offen offset:2048 sc1
    v_mfma_f32_16x16x32_bf16 v[56:59], v[252:255], a[204:207], v[56:59]
    v_mov_b32 v10, s51
    buffer_load_dwordx4 a[252:255], v4, s[28:31], s49 offen offset:3072 sc1
    s_mov_b32 s52, 0
    v_mfma_f32_16x16x32_bf16 v[28:31], v[248:251], a[220:223], v[28:31]
    v_mfma_f32_16x16x32_bf16 v[32:35], v[252:255], a[220:223], v[32:35]
    s_nop 7
L_fj:
    v_pk_fma_f32 v[28:29], v[10:11], v[44:45], v[28:29] op_sel_hi:[0,1,1]
    s_waitcnt vmcnt(20)
    ds_read_b128 a[0:3], v14 offset:0
    v_pk_fma_f32 v[30:31], v[10:11], v[46:47], v[30:31] op_sel_hi:[0,1,1]
    ds_read_b128 a[4:7], v20 offset:0
    v_pk_fma_f32 v[32:33], v[10:11], v[48:49], v[32:33] op_sel_hi:[0,1,1]
    v_pk_fma_f32 v[34:35], v[10:11], v[50:51], v[34:35] op_sel_hi:[0,1,1]
    ds_read_b128 a[8:11], v21 offset:0
    v_pk_fma_f32 v[36:37], v[10:11], v[52:53], v[36:37] op_sel_hi:[0,1,1]
    v_pk_fma_f32 v[38:39], v[10:11], v[54:55], v[38:39] op_sel_hi:[0,1,1]
    ds_read_b128 a[12:15], v112 offset:0
    v_pk_fma_f32 v[40:41], v[10:11], v[56:57], v[40:41] op_sel_hi:[0,1,1]
    v_pk_fma_f32 v[42:43], v[10:11], v[58:59], v[42:43] op_sel_hi:[0,1,1]
    ds_read_b128 a[16:19], v14 offset:64
    s_waitcnt lgkmcnt(11)
    v_pk_mul_f32 v[28:29], v[28:29], v[60:61]
    s_waitcnt lgkmcnt(9)
    v_pk_mul_f32 v[30:31], v[30:31], v[62:63]
    ds_read_b128 a[20:23], v20 offset:64
    s_waitcnt lgkmcnt(8)
    v_pk_mul_f32 v[32:33], v[32:33], v[64:65]
    s_waitcnt lgkmcnt(6)
    v_pk_mul_f32 v[34:35], v[34:35], v[66:67]
    ds_read_b128 a[24:27], v21 offset:64
    v_pk_mul_f32 v[36:37], v[36:37], v[60:61]
    ds_read_b128 a[28:31], v112 offset:64
    v_pk_mul_f32 v[38:39], v[38:39], v[62:63]
    v_pk_mul_f32 v[40:41], v[40:41], v[64:65]
    s_add_u32 m0, s53, 0
    s_waitcnt lgkmcnt(0)
    buffer_load_dwordx4 v5, s[16:19], s96 offen offset:0  lds
    v_pk_mul_f32 v[42:43], v[42:43], v[66:67]
    v_cvt_pk_bf16_f32 v68, v28, v29
    buffer_load_dwordx4 v5, s[16:19], s97 offen offset:1088  lds
    v_cvt_pk_bf16_f32 v76, -v28, -v29
    v_cvt_pk_bf16_f32 v72, v36, v37
    buffer_load_dwordx4 v5, s[16:19], s98 offen offset:2176  lds
    v_cvt_pk_bf16_f32 v69, v30, v31
    v_cvt_pk_bf16_f32 v77, -v30, -v31
    buffer_load_dwordx4 v5, s[16:19], s99 offen offset:3264  lds
    v_cvt_pk_bf16_f32 v73, v38, v39
    v_cvt_pk_bf16_f32 v70, v32, v33
    v_xor_b32 v5, 1024, v5
    s_add_u32 m0, s53, 4352
    s_nop 0
    buffer_load_dwordx4 v5, s[16:19], 0 offen offset:0  lds
    v_cvt_pk_bf16_f32 v78, -v32, -v33
    buffer_load_dwordx4 v5, s[16:19], s93 offen offset:1088  lds
    v_cvt_pk_bf16_f32 v74, v40, v41
    v_cvt_pk_bf16_f32 v71, v34, v35
    buffer_load_dwordx4 v5, s[16:19], s94 offen offset:2176  lds
    v_cvt_pk_bf16_f32 v79, -v34, -v35
    v_cvt_pk_bf16_f32 v75, v42, v43
    buffer_load_dwordx4 v5, s[16:19], s95 offen offset:3264  lds
    v_mfma_f32_16x16x32_bf16 v[44:47], v[68:71], a[224:227], 0
    v_mfma_f32_16x16x32_bf16 v[48:51], v[72:75], a[224:227], 0
    s_waitcnt vmcnt(19)
    ds_read_b128 a[32:35], v14 offset:8704
    v_mfma_f32_16x16x32_bf16 v[44:47], v[72:75], a[232:235], v[44:47]
    v_mfma_f32_16x16x32_bf16 v[48:51], v[76:79], a[232:235], v[48:51]
    ds_read_b128 a[36:39], v20 offset:8704
    v_mfma_f32_16x16x32_bf16 v[52:55], v[68:71], a[228:231], 0
    v_mfma_f32_16x16x32_bf16 v[56:59], v[72:75], a[228:231], 0
    ds_read_b128 a[40:43], v21 offset:8704
    v_mfma_f32_16x16x32_bf16 v[52:55], v[72:75], a[236:239], v[52:55]
    ds_read_b128 a[44:47], v112 offset:8704
    v_mfma_f32_16x16x32_bf16 v[56:59], v[76:79], a[236:239], v[56:59]
    s_nop 0
    v_cvt_pk_bf16_f32 v60, v44, v48
    ds_read_b128 a[48:51], v14 offset:8768
    v_cvt_pk_bf16_f32 v61, v45, v49
    v_cvt_pk_bf16_f32 v62, v46, v50
    ds_read_b128 a[52:55], v20 offset:8768
    v_cvt_pk_bf16_f32 v63, v47, v51
    s_nop 0
    v_cvt_pk_bf16_f32 v64, v52, v56
    ds_read_b128 a[56:59], v21 offset:8768
    v_cvt_pk_bf16_f32 v65, v53, v57
    v_cvt_pk_bf16_f32 v66, v54, v58
    ds_read_b128 a[60:63], v112 offset:8768
    v_cvt_pk_bf16_f32 v67, v55, v59
    s_mov_b32 s50, 4194304
    buffer_store_dwordx4 v[60:63], v113, s[28:31], s50 offen sc1
    s_mov_b32 s50, 5246976
    buffer_store_dwordx4 v[64:67], v113, s[28:31], s50 offen sc1
    s_waitcnt vmcnt(14)
L_r1:
    s_waitcnt vmcnt(13)
    v_accvgpr_read_b32 v28, a240
    v_accvgpr_read_b32 v29, a241
    v_accvgpr_read_b32 v30, a242
    v_accvgpr_read_b32 v31, a243
    s_waitcnt vmcnt(12)
    v_accvgpr_read_b32 v32, a244
    v_accvgpr_read_b32 v33, a245
    v_accvgpr_read_b32 v34, a246
    v_accvgpr_read_b32 v35, a247
    s_waitcnt vmcnt(11)
    v_accvgpr_read_b32 v36, a248
    v_accvgpr_read_b32 v37, a249
    v_accvgpr_read_b32 v38, a250
    v_accvgpr_read_b32 v39, a251
    s_waitcnt vmcnt(10)
    v_accvgpr_read_b32 v40, a252
    v_accvgpr_read_b32 v41, a253
    v_accvgpr_read_b32 v42, a254
    v_accvgpr_read_b32 v43, a255
    v_xor_b32 v6, s43, v28
    v_xor_b32 v7, s56, v29
    v_bitop3_b32 v6, v30, s57, v6 bitop3:0xbe
    v_bitop3_b32 v7, v31, s58, v7 bitop3:0xbe
    v_bitop3_b32 v6, v32, s43, v6 bitop3:0xbe
    v_bitop3_b32 v7, v33, s56, v7 bitop3:0xbe
    v_bitop3_b32 v6, v34, s57, v6 bitop3:0xbe
    v_bitop3_b32 v7, v35, s58, v7 bitop3:0xbe
    v_bitop3_b32 v6, v36, s43, v6 bitop3:0xbe
    v_bitop3_b32 v7, v37, s56, v7 bitop3:0xbe
    v_bitop3_b32 v6, v38, s57, v6 bitop3:0xbe
    v_bitop3_b32 v7, v39, s58, v7 bitop3:0xbe
    v_bitop3_b32 v6, v40, s43, v6 bitop3:0xbe
    v_bitop3_b32 v7, v41, s56, v7 bitop3:0xbe
    v_bitop3_b32 v6, v42, s57, v6 bitop3:0xbe
    v_bitop3_b32 v7, v43, s58, v7 bitop3:0xbe
    v_bitop3_b32 v6, v6, v7, s59 bitop3:0xa8
    v_cmp_ne_u32 vcc, 0, v6
    s_cbranch_vccnz L_s1
L_b1:
    v_pk_add_f32 v[28:29], v[28:29], v[32:33]
    s_add_u32 m0, s53, 8704
    s_waitcnt lgkmcnt(0)
    buffer_load_dwordx4 v5, s[16:19], s96 offen offset:0  lds
    v_pk_add_f32 v[36:37], v[36:37], v[40:41]
    v_pk_add_f32 v[30:31], v[30:31], v[34:35]
    v_pk_add_f32 v[38:39], v[38:39], v[42:43]
    v_pk_add_f32 v[28:29], v[28:29], v[36:37]
    v_pk_add_f32 v[30:31], v[30:31], v[38:39]
    buffer_load_dwordx4 v5, s[16:19], s97 offen offset:1088  lds
    s_nop 0
    v_permlane16_swap_b32 v28, v30
    v_permlane16_swap_b32 v29, v31
    v_pk_add_f32 v[32:33], v[28:29], v[30:31]
    v_pk_add_f32 v[28:29], v[28:29], v[30:31]
    s_nop 1
    v_permlane32_swap_b32 v28, v32
    buffer_load_dwordx4 v5, s[16:19], s98 offen offset:2176  lds
    v_permlane32_swap_b32 v29, v33
    v_pk_add_f32 v[28:29], v[28:29], v[32:33]
    v_mul_f32 v6, 0xbabe82fa, v28
    v_mul_f32 v7, v6, v6
    v_sub_f32 v7, 0x3727c5ac, v7
    buffer_load_dwordx4 v5, s[16:19], s99 offen offset:3264  lds
    v_fmamk_f32 v7, v29, 0x3abe82fa, v7
    v_max_f32 v7, 0x3727c5ac, v7
    v_rsq_f32 v8, v7
    s_nop 0
    v_mul_f32 v9, v6, v8
    v_pk_fma_f32 v[80:81], v[80:81], v[8:9], v[8:9] op_sel:[0,0,1] op_sel_hi:[1,0,1]
    v_pk_fma_f32 v[82:83], v[82:83], v[8:9], v[8:9] op_sel:[0,0,1] op_sel_hi:[1,0,1]
    v_pk_fma_f32 v[84:85], v[84:85], v[8:9], v[8:9] op_sel:[0,0,1] op_sel_hi:[1,0,1]
    v_pk_fma_f32 v[86:87], v[86:87], v[8:9], v[8:9] op_sel:[0,0,1] op_sel_hi:[1,0,1]
    v_cvt_pk_bf16_f32 v44, v80, v81
    v_cvt_pk_bf16_f32 v45, v82, v83
    v_cvt_pk_bf16_f32 v46, v84, v85
    v_cvt_pk_bf16_f32 v47, v86, v87
    s_mov_b32 s50, 1048576
    buffer_store_dwordx4 v[44:47], v124, s[28:31], s50 offen sc1
    v_pk_fma_f32 v[88:89], v[88:89], v[8:9], v[8:9] op_sel:[0,0,1] op_sel_hi:[1,0,1]
    v_pk_fma_f32 v[90:91], v[90:91], v[8:9], v[8:9] op_sel:[0,0,1] op_sel_hi:[1,0,1]
    v_pk_fma_f32 v[92:93], v[92:93], v[8:9], v[8:9] op_sel:[0,0,1] op_sel_hi:[1,0,1]
    v_pk_fma_f32 v[94:95], v[94:95], v[8:9], v[8:9] op_sel:[0,0,1] op_sel_hi:[1,0,1]
    v_cvt_pk_bf16_f32 v48, v88, v89
    v_cvt_pk_bf16_f32 v49, v90, v91
    v_cvt_pk_bf16_f32 v50, v92, v93
    v_cvt_pk_bf16_f32 v51, v94, v95
    s_mov_b32 s50, 1081344
    buffer_store_dwordx4 v[48:51], v124, s[28:31], s50 offen sc1
    v_pk_fma_f32 v[96:97], v[96:97], v[8:9], v[8:9] op_sel:[0,0,1] op_sel_hi:[1,0,1]
    v_pk_fma_f32 v[98:99], v[98:99], v[8:9], v[8:9] op_sel:[0,0,1] op_sel_hi:[1,0,1]
    v_pk_fma_f32 v[100:101], v[100:101], v[8:9], v[8:9] op_sel:[0,0,1] op_sel_hi:[1,0,1]
    v_pk_fma_f32 v[102:103], v[102:103], v[8:9], v[8:9] op_sel:[0,0,1] op_sel_hi:[1,0,1]
    v_cvt_pk_bf16_f32 v52, v96, v97
    v_cvt_pk_bf16_f32 v53, v98, v99
    v_cvt_pk_bf16_f32 v54, v100, v101
    v_cvt_pk_bf16_f32 v55, v102, v103
    s_mov_b32 s50, 1114112
    buffer_store_dwordx4 v[52:55], v125, s[28:31], s50 offen sc1
    v_lshlrev_b32 v6, 2, v0
    v_cmp_gt_u32 vcc, 32, v0
    v_mov_b32 v7, 2146435072
    v_mov_b32 v18, s43
    v_cndmask_b32 v113, v7, v6, vcc
    v_and_b32 v6, 8, v1
    v_mul_u32_u24 v6, 2720, v6
    v_sub_u32 v10, v14, v6
    v_sub_u32 v11, v20, v6
    v_sub_u32 v12, v21, v6
    v_sub_u32 v13, v112, v6
    s_lshl_b32 s47, s37, 2
    s_add_u32 s47, s47, s38
    s_lshr_b32 s48, s45, 10
    s_xor_b32 s48, s48, s47
    s_mul_i32 s48, s48, 98304
    v_add_u32 v125, s48, v4
    s_lshl_b32 s54, s38, 12
    v_and_b32 v6, 7, v1
    v_lshlrev_b32 v126, 7, v6
    s_lshl_b32 s47, s47, 10
    s_add_u32 s49, s47, 4096
    s_lshl_b32 s47, s37, 5
    s_add_u32 s47, s47, s36
    s_lshl_b32 s47, s47, 7
    s_add_u32 s47, s47, 4096
    s_barrier
    ds_read_b64_tr_b16 v[56:57], v22 offset:24576
    ds_read_b64_tr_b16 v[58:59], v22 offset:25344
    ds_read_b64_tr_b16 v[60:61], v22 offset:24640
    ds_read_b64_tr_b16 v[62:63], v22 offset:25408
    ds_read_b64_tr_b16 v[64:65], v22 offset:24704
    ds_read_b64_tr_b16 v[66:67], v22 offset:25472
    s_waitcnt lgkmcnt(4)
    v_mfma_f32_16x16x32_bf16 v[80:83], v[56:59], v[128:131], 0
    ds_read_b64_tr_b16 v[68:69], v23 offset:24576
    s_waitcnt vmcnt(13)
    v_mfma_f32_16x16x32_bf16 v[84:87], v[56:59], v[132:135], 0
    ds_read_b64_tr_b16 v[70:71], v23 offset:25344
    ds_read_b64_tr_b16 v[72:73], v23 offset:24640
    v_mfma_f32_16x16x32_bf16 v[28:31], v[56:59], v[24:27], 0
    ds_read_b64_tr_b16 v[74:75], v23 offset:25408
    ds_read_b128 a[64:67], v10 offset:17408
    s_waitcnt lgkmcnt(7)
    v_mfma_f32_16x16x32_bf16 v[88:91], v[60:63], v[128:131], 0
    ds_read_b64_tr_b16 v[76:77], v23 offset:24704
    ds_read_b128 a[68:71], v11 offset:17408
    v_mfma_f32_16x16x32_bf16 v[92:95], v[60:63], v[132:135], 0
    ds_read_b64_tr_b16 v[78:79], v23 offset:25472
    ds_read_b128 a[72:75], v12 offset:17408
    v_mfma_f32_16x16x32_bf16 v[32:35], v[60:63], v[24:27], 0
    s_waitcnt lgkmcnt(9)
    v_mfma_f32_16x16x32_bf16 v[96:99], v[64:67], v[128:131], 0
    ds_read_b128 a[76:79], v13 offset:17408
    v_mfma_f32_16x16x32_bf16 v[100:103], v[64:67], v[132:135], 0
    ds_read_b128 a[80:83], v10 offset:17472
    s_waitcnt lgkmcnt(3)
    v_mfma_f32_16x16x32_bf16 v[80:83], v[68:71], v[136:139], v[80:83]
    ds_read_b64_tr_b16 v[56:57], v22 offset:36864
    ds_read_b128 a[84:87], v11 offset:17472
    v_mfma_f32_16x16x32_bf16 v[84:87], v[68:71], v[140:143], v[84:87]
    ds_read_b64_tr_b16 v[58:59], v22 offset:37632
    ds_read_b64_tr_b16 v[60:61], v22 offset:36928
    v_mfma_f32_16x16x32_bf16 v[88:91], v[72:75], v[136:139], v[88:91]
    ds_read_b64_tr_b16 v[62:63], v22 offset:37696
    ds_read_b128 a[88:91], v12 offset:17472
    v_mfma_f32_16x16x32_bf16 v[92:95], v[72:75], v[140:143], v[92:95]
    ds_read_b64_tr_b16 v[64:65], v22 offset:36992
    ds_read_b64_tr_b16 v[66:67], v22 offset:37760
    v_mfma_f32_16x16x32_bf16 v[96:99], v[76:79], v[136:139], v[96:99]
    ds_read_b128 a[92:95], v13 offset:17472
    s_mul_i32 s48, s38, 768
    v_mfma_f32_16x16x32_bf16 v[100:103], v[76:79], v[140:143], v[100:103]
    s_add_u32 s48, s48, 160768
    v_mfma_f32_16x16x32_bf16 v[36:39], v[76:79], v[24:27], 0
    s_waitcnt lgkmcnt(1)
    v_mfma_f32_16x16x32_bf16 v[80:83], v[56:59], v[144:147], v[80:83]
    ds_read_b64_tr_b16 v[68:69], v23 offset:36864
    s_add_u32 s48, s48, 512
    v_mfma_f32_16x16x32_bf16 v[84:87], v[56:59], v[148:151], v[84:87]
    ds_read_b64_tr_b16 v[70:71], v23 offset:37632
    v_lshl_add_u32 v9, v1, 2, s48
    v_mfma_f32_16x16x32_bf16 v[28:31], v[56:59], v[24:27], v[28:31]
    ds_read_b64_tr_b16 v[72:73], v23 offset:36928
    s_xor_b32 s48, s38, 2
    v_mfma_f32_16x16x32_bf16 v[88:91], v[60:63], v[144:147], v[88:91]
    ds_read_b64_tr_b16 v[74:75], v23 offset:37696
    ds_read_b64_tr_b16 v[76:77], v23 offset:36992
    v_mfma_f32_16x16x32_bf16 v[92:95], v[60:63], v[148:151], v[92:95]
    ds_read_b64_tr_b16 v[78:79], v23 offset:37760
    s_mul_i32 s48, s48, 768
    v_mfma_f32_16x16x32_bf16 v[32:35], v[60:63], v[24:27], v[32:35]
    s_add_u32 s48, s48, 161280
    v_mfma_f32_16x16x32_bf16 v[96:99], v[64:67], v[144:147], v[96:99]
    v_lshl_add_u32 v8, v3, 6, s48
    v_mfma_f32_16x16x32_bf16 v[100:103], v[64:67], v[148:151], v[100:103]
    s_waitcnt lgkmcnt(0)
    s_barrier
    v_mfma_f32_16x16x32_bf16 v[80:83], v[68:71], v[152:155], v[80:83]
    ds_read_b64_tr_b16 v[56:57], v22 offset:49152
    s_add_u32 s4, s4, 128
    v_mfma_f32_16x16x32_bf16 v[84:87], v[68:71], v[156:159], v[84:87]
    ds_read_b64_tr_b16 v[58:59], v22 offset:49920
    s_and_b32 s4, s4, 0x380
    v_mfma_f32_16x16x32_bf16 v[88:91], v[72:75], v[152:155], v[88:91]
    ds_read_b64_tr_b16 v[60:61], v22 offset:49216
    ds_read_b64_tr_b16 v[62:63], v22 offset:49984
    v_mfma_f32_16x16x32_bf16 v[92:95], v[72:75], v[156:159], v[92:95]
    ds_read_b64_tr_b16 v[64:65], v22 offset:49280
    ds_read_b64_tr_b16 v[66:67], v22 offset:50048
    v_mfma_f32_16x16x32_bf16 v[96:99], v[76:79], v[152:155], v[96:99]
    s_add_u32 m0, s46, 24576
    s_mul_i32 s5, s4, 1376
    v_mfma_f32_16x16x32_bf16 v[100:103], v[76:79], v[156:159], v[100:103]
    buffer_load_dwordx4 v15, s[12:15], s5 offen  lds
    v_mfma_f32_16x16x32_bf16 v[36:39], v[76:79], v[24:27], v[36:39]
    s_waitcnt lgkmcnt(0)
    v_mfma_f32_16x16x32_bf16 v[80:83], v[56:59], v[160:163], v[80:83]
    buffer_load_dwordx4 v16, s[12:15], s5 offen offset:1024  lds
    v_mfma_f32_16x16x32_bf16 v[84:87], v[56:59], v[164:167], v[84:87]
    buffer_load_dwordx4 v17, s[12:15], s5 offen offset:2048  lds
    v_mfma_f32_16x16x32_bf16 v[28:31], v[56:59], v[24:27], v[28:31]
    ds_read_b64_tr_b16 v[68:69], v23 offset:49152
    ds_read_b64_tr_b16 v[70:71], v23 offset:49920
    v_mfma_f32_16x16x32_bf16 v[88:91], v[60:63], v[160:163], v[88:91]
    ds_read_b64_tr_b16 v[72:73], v23 offset:49216
    ds_read_b64_tr_b16 v[74:75], v23 offset:49984
    v_mfma_f32_16x16x32_bf16 v[92:95], v[60:63], v[164:167], v[92:95]
    ds_read_b64_tr_b16 v[76:77], v23 offset:49280
    ds_read_b64_tr_b16 v[78:79], v23 offset:50048
    v_mfma_f32_16x16x32_bf16 v[32:35], v[60:63], v[24:27], v[32:35]
    s_add_u32 s4, s4, 128
    s_and_b32 s4, s4, 0x380
    v_mfma_f32_16x16x32_bf16 v[96:99], v[64:67], v[160:163], v[96:99]
    s_add_u32 m0, s46, 36864
    s_mul_i32 s5, s4, 1376
    v_mfma_f32_16x16x32_bf16 v[100:103], v[64:67], v[164:167], v[100:103]
    s_waitcnt lgkmcnt(0)
    v_mfma_f32_16x16x32_bf16 v[80:83], v[68:71], v[168:171], v[80:83]
    buffer_load_dwordx4 v15, s[12:15], s5 offen  lds
    v_mfma_f32_16x16x32_bf16 v[84:87], v[68:71], v[172:175], v[84:87]
    ds_read_b64_tr_b16 v[56:57], v22 offset:61440
    ds_read_b64_tr_b16 v[58:59], v22 offset:62208
    v_mfma_f32_16x16x32_bf16 v[88:91], v[72:75], v[168:171], v[88:91]
    ds_read_b64_tr_b16 v[60:61], v22 offset:61504
    ds_read_b64_tr_b16 v[62:63], v22 offset:62272
    v_mfma_f32_16x16x32_bf16 v[92:95], v[72:75], v[172:175], v[92:95]
    ds_read_b64_tr_b16 v[64:65], v22 offset:61568
    ds_read_b64_tr_b16 v[66:67], v22 offset:62336
    v_mfma_f32_16x16x32_bf16 v[96:99], v[76:79], v[168:171], v[96:99]
    buffer_load_dwordx4 v16, s[12:15], s5 offen offset:1024  lds
    v_mfma_f32_16x16x32_bf16 v[100:103], v[76:79], v[172:175], v[100:103]
    buffer_load_dwordx4 v17, s[12:15], s5 offen offset:2048  lds
    v_mfma_f32_16x16x32_bf16 v[36:39], v[76:79], v[24:27], v[36:39]
    v_xor_b32 v5, 1792, v5
    s_waitcnt lgkmcnt(0)
    v_mfma_f32_16x16x32_bf16 v[80:83], v[56:59], v[176:179], v[80:83]
    ds_read_b64_tr_b16 v[68:69], v23 offset:61440
    s_add_u32 m0, s53, 13056
    v_mfma_f32_16x16x32_bf16 v[84:87], v[56:59], v[180:183], v[84:87]
    buffer_load_dwordx4 v5, s[16:19], 0 offen offset:0  lds
    v_mfma_f32_16x16x32_bf16 v[28:31], v[56:59], v[24:27], v[28:31]
    ds_read_b64_tr_b16 v[70:71], v23 offset:62208
    ds_read_b64_tr_b16 v[72:73], v23 offset:61504
    v_mfma_f32_16x16x32_bf16 v[88:91], v[60:63], v[176:179], v[88:91]
    ds_read_b64_tr_b16 v[74:75], v23 offset:62272
    ds_read_b64_tr_b16 v[76:77], v23 offset:61568
    v_mfma_f32_16x16x32_bf16 v[92:95], v[60:63], v[180:183], v[92:95]
    ds_read_b64_tr_b16 v[78:79], v23 offset:62336
    v_mfma_f32_16x16x32_bf16 v[32:35], v[60:63], v[24:27], v[32:35]
    buffer_load_dwordx4 v5, s[16:19], s93 offen offset:1088  lds
    v_mfma_f32_16x16x32_bf16 v[96:99], v[64:67], v[176:179], v[96:99]
    buffer_load_dwordx4 v5, s[16:19], s94 offen offset:2176  lds
    v_mfma_f32_16x16x32_bf16 v[100:103], v[64:67], v[180:183], v[100:103]
    s_waitcnt lgkmcnt(0)
    v_mfma_f32_16x16x32_bf16 v[80:83], v[68:71], v[184:187], v[80:83]
    buffer_load_dwordx4 v5, s[16:19], s95 offen offset:3264  lds
    v_mfma_f32_16x16x32_bf16 v[84:87], v[68:71], v[188:191], v[84:87]
    ds_read_b64_tr_b16 v[56:57], v22 offset:0
    ds_read_b64_tr_b16 v[58:59], v22 offset:768
    v_mfma_f32_16x16x32_bf16 v[88:91], v[72:75], v[184:187], v[88:91]
    ds_read_b64_tr_b16 v[60:61], v22 offset:64
    ds_read_b64_tr_b16 v[62:63], v22 offset:832
    v_mfma_f32_16x16x32_bf16 v[92:95], v[72:75], v[188:191], v[92:95]
    ds_read_b64_tr_b16 v[64:65], v22 offset:128
    ds_read_b64_tr_b16 v[66:67], v22 offset:896
    v_mfma_f32_16x16x32_bf16 v[96:99], v[76:79], v[184:187], v[96:99]
    buffer_load_dword v19, v19, s[20:23], 0 offen
    v_mfma_f32_16x16x32_bf16 v[100:103], v[76:79], v[188:191], v[100:103]
    s_add_u32 m0, s53, 17408
    s_nop 0
    buffer_load_dwordx4 v5, s[16:19], s96 offen offset:0  lds
    buffer_load_dwordx4 v5, s[16:19], s97 offen offset:1088  lds
    buffer_load_dwordx4 v5, s[16:19], s98 offen offset:2176  lds
    buffer_load_dwordx4 v5, s[16:19], s99 offen offset:3264  lds
    v_mfma_f32_16x16x32_bf16 v[36:39], v[76:79], v[24:27], v[36:39]
    s_waitcnt lgkmcnt(0)
    s_waitcnt vmcnt(15)
    s_barrier
    v_mfma_f32_16x16x32_bf16 v[80:83], v[56:59], v[192:195], v[80:83]
    buffer_store_dword v18, v113, s[28:31], s47 offen sc1
    v_mfma_f32_16x16x32_bf16 v[84:87], v[56:59], v[196:199], v[84:87]
    ds_read_b64_tr_b16 v[68:69], v23 offset:0
    ds_read_b64_tr_b16 v[70:71], v23 offset:768
    v_mfma_f32_16x16x32_bf16 v[28:31], v[56:59], v[24:27], v[28:31]
    ds_read_b64_tr_b16 v[72:73], v23 offset:64
    ds_read_b64_tr_b16 v[74:75], v23 offset:832
    v_mfma_f32_16x16x32_bf16 v[88:91], v[60:63], v[192:195], v[88:91]
    ds_read_b64_tr_b16 v[76:77], v23 offset:128
    v_xor_b32 v5, 1024, v5
    v_mfma_f32_16x16x32_bf16 v[92:95], v[60:63], v[196:199], v[92:95]
    ds_read_b64_tr_b16 v[78:79], v23 offset:896
    s_add_u32 m0, s53, 0
    v_mfma_f32_16x16x32_bf16 v[32:35], v[60:63], v[24:27], v[32:35]
    buffer_load_dwordx4 v5, s[16:19], 0 offen offset:0  lds
    v_mfma_f32_16x16x32_bf16 v[96:99], v[64:67], v[192:195], v[96:99]
    v_mfma_f32_16x16x32_bf16 v[100:103], v[64:67], v[196:199], v[100:103]
    s_waitcnt lgkmcnt(0)
    v_mfma_f32_16x16x32_bf16 v[80:83], v[68:71], v[200:203], v[80:83]
    buffer_load_dwordx4 v5, s[16:19], s93 offen offset:1088  lds
    v_mfma_f32_16x16x32_bf16 v[84:87], v[68:71], v[204:207], v[84:87]
    ds_read_b64_tr_b16 v[56:57], v22 offset:12288
    ds_read_b64_tr_b16 v[58:59], v22 offset:13056
    v_mfma_f32_16x16x32_bf16 v[88:91], v[72:75], v[200:203], v[88:91]
    ds_read_b64_tr_b16 v[60:61], v22 offset:12352
    ds_read_b64_tr_b16 v[62:63], v22 offset:13120
    v_mfma_f32_16x16x32_bf16 v[92:95], v[72:75], v[204:207], v[92:95]
    ds_read_b64_tr_b16 v[64:65], v22 offset:12416
    ds_read_b64_tr_b16 v[66:67], v22 offset:13184
    v_mfma_f32_16x16x32_bf16 v[96:99], v[76:79], v[200:203], v[96:99]
    buffer_load_dwordx4 v5, s[16:19], s94 offen offset:2176  lds
    v_mfma_f32_16x16x32_bf16 v[100:103], v[76:79], v[204:207], v[100:103]
    buffer_load_dwordx4 v5, s[16:19], s95 offen offset:3264  lds
    v_mfma_f32_16x16x32_bf16 v[36:39], v[76:79], v[24:27], v[36:39]
    s_waitcnt lgkmcnt(0)
    v_mfma_f32_16x16x32_bf16 v[80:83], v[56:59], v[208:211], v[80:83]
    ds_read_b64_tr_b16 v[68:69], v23 offset:12288
    ds_read_b128 a[96:99], v14 offset:4352
    v_mfma_f32_16x16x32_bf16 v[84:87], v[56:59], v[212:215], v[84:87]
    ds_read_b64_tr_b16 v[70:71], v23 offset:13056
    ds_read_b64_tr_b16 v[72:73], v23 offset:12352
    v_mfma_f32_16x16x32_bf16 v[28:31], v[56:59], v[24:27], v[28:31]
    ds_read_b64_tr_b16 v[74:75], v23 offset:13120
    ds_read_b128 a[100:103], v20 offset:4352
    v_mfma_f32_16x16x32_bf16 v[88:91], v[60:63], v[208:211], v[88:91]
    ds_read_b64_tr_b16 v[76:77], v23 offset:12416
    ds_read_b128 a[104:107], v21 offset:4352
    v_mfma_f32_16x16x32_bf16 v[92:95], v[60:63], v[212:215], v[92:95]
    ds_read_b64_tr_b16 v[78:79], v23 offset:13184
    ds_read_b128 a[108:111], v112 offset:4352
    v_mfma_f32_16x16x32_bf16 v[32:35], v[60:63], v[24:27], v[32:35]
    ds_read_b128 a[112:115], v14 offset:4416
    v_mfma_f32_16x16x32_bf16 v[96:99], v[64:67], v[208:211], v[96:99]
    ds_read_b128 a[116:119], v20 offset:4416
    v_mfma_f32_16x16x32_bf16 v[100:103], v[64:67], v[212:215], v[100:103]
    ds_read_b128 a[120:123], v21 offset:4416
    s_waitcnt lgkmcnt(4)
    s_waitcnt vmcnt(14)
    s_barrier
    v_mfma_f32_16x16x32_bf16 v[80:83], v[68:71], v[216:219], v[80:83]
    ds_read_b64_tr_b16 v[56:57], v22 offset:24576
    ds_read_b64_tr_b16 v[58:59], v22 offset:25344
    v_mfma_f32_16x16x32_bf16 v[84:87], v[68:71], v[220:223], v[84:87]
    ds_read_b64_tr_b16 v[60:61], v22 offset:24640
    ds_read_b128 a[124:127], v112 offset:4416
    v_mfma_f32_16x16x32_bf16 v[88:91], v[72:75], v[216:219], v[88:91]
    ds_read_b64_tr_b16 v[62:63], v22 offset:25408
    s_add_u32 m0, s53, 4352
    v_mfma_f32_16x16x32_bf16 v[92:95], v[72:75], v[220:223], v[92:95]
    ds_read_b64_tr_b16 v[64:65], v22 offset:24704
    ds_read_b64_tr_b16 v[66:67], v22 offset:25472
    v_mfma_f32_16x16x32_bf16 v[96:99], v[76:79], v[216:219], v[96:99]
    s_waitcnt lgkmcnt(3)
    v_mfma_f32_16x16x32_bf16 v[100:103], v[76:79], v[220:223], v[100:103]
    buffer_load_dwordx4 v5, s[16:19], s96 offen offset:0  lds
    v_mfma_f32_16x16x32_bf16 v[36:39], v[76:79], v[24:27], v[36:39]
    s_waitcnt lgkmcnt(0)
    v_mfma_f32_16x16x32_bf16 v[80:83], v[56:59], v[224:227], v[80:83]
    buffer_load_dwordx4 v5, s[16:19], s97 offen offset:1088  lds
    v_mfma_f32_16x16x32_bf16 v[84:87], v[56:59], v[228:231], v[84:87]
    ds_read_b64_tr_b16 v[68:69], v23 offset:24576
    ds_read_b64_tr_b16 v[70:71], v23 offset:25344
    v_mfma_f32_16x16x32_bf16 v[28:31], v[56:59], v[24:27], v[28:31]
    buffer_load_dwordx4 v5, s[16:19], s98 offen offset:2176  lds
    v_mfma_f32_16x16x32_bf16 v[88:91], v[60:63], v[224:227], v[88:91]
    ds_read_b64_tr_b16 v[72:73], v23 offset:24640
    ds_read_b64_tr_b16 v[74:75], v23 offset:25408
    v_mfma_f32_16x16x32_bf16 v[92:95], v[60:63], v[228:231], v[92:95]
    ds_read_b64_tr_b16 v[76:77], v23 offset:24704
    ds_read_b64_tr_b16 v[78:79], v23 offset:25472
    v_mfma_f32_16x16x32_bf16 v[32:35], v[60:63], v[24:27], v[32:35]
    buffer_load_dwordx4 v5, s[16:19], s99 offen offset:3264  lds
    v_mfma_f32_16x16x32_bf16 v[96:99], v[64:67], v[224:227], v[96:99]
    v_xor_b32 v5, 1280, v5
    v_mfma_f32_16x16x32_bf16 v[100:103], v[64:67], v[228:231], v[100:103]
    s_add_u32 m0, s53, 8704
    s_waitcnt lgkmcnt(0)
    v_mfma_f32_16x16x32_bf16 v[80:83], v[68:71], v[232:235], v[80:83]
    ds_read_b64_tr_b16 v[56:57], v22 offset:36864
    ds_read_b64_tr_b16 v[58:59], v22 offset:37632
    v_mfma_f32_16x16x32_bf16 v[84:87], v[68:71], v[236:239], v[84:87]
    buffer_load_dwordx4 v5, s[16:19], 0 offen offset:0  lds
    v_mfma_f32_16x16x32_bf16 v[88:91], v[72:75], v[232:235], v[88:91]
    ds_read_b64_tr_b16 v[60:61], v22 offset:36928
    ds_read_b64_tr_b16 v[62:63], v22 offset:37696
    v_mfma_f32_16x16x32_bf16 v[92:95], v[72:75], v[236:239], v[92:95]
    ds_read_b64_tr_b16 v[64:65], v22 offset:36992
    ds_read_b64_tr_b16 v[66:67], v22 offset:37760
    v_mfma_f32_16x16x32_bf16 v[96:99], v[76:79], v[232:235], v[96:99]
    buffer_load_dwordx4 v5, s[16:19], s93 offen offset:1088  lds
    v_mfma_f32_16x16x32_bf16 v[100:103], v[76:79], v[236:239], v[100:103]
    buffer_load_dwordx4 v5, s[16:19], s94 offen offset:2176  lds
    v_mfma_f32_16x16x32_bf16 v[36:39], v[76:79], v[24:27], v[36:39]
    s_waitcnt lgkmcnt(0)
    v_mfma_f32_16x16x32_bf16 v[28:31], v[56:59], v[24:27], v[28:31]
    buffer_load_dwordx4 v5, s[16:19], s95 offen offset:3264  lds
    v_mfma_f32_16x16x32_bf16 v[32:35], v[60:63], v[24:27], v[32:35]
    ds_read_b64_tr_b16 v[68:69], v23 offset:36864
    ds_read_b64_tr_b16 v[70:71], v23 offset:37632
    v_mfma_f32_16x16x32_bf16 v[36:39], v[64:67], v[24:27], v[36:39]
    s_mov_b32 vcc_lo, 0xf0f0f0f0
    s_mov_b32 vcc_hi, 0xf0f0f0f0
    ds_read_b64_tr_b16 v[72:73], v23 offset:36928
    ds_read_b64_tr_b16 v[74:75], v23 offset:37696
    v_mfma_f32_16x16x32_bf16 v[80:83], v[56:59], v[240:243], v[80:83]
    v_cndmask_b32 v48, v28, v29, s[62:63]
    v_cndmask_b32 v49, v30, v31, s[62:63]
    ds_read_b64_tr_b16 v[76:77], v23 offset:36992
    s_waitcnt vmcnt(13)
    v_mfma_f32_16x16x32_bf16 v[84:87], v[56:59], v[244:247], v[84:87]
    v_cndmask_b32 v48, v48, v49, s[64:65]
    ds_read_b64_tr_b16 v[78:79], v23 offset:37760
    ds_read_b128 a[128:131], v14 offset:13056
    v_mfma_f32_16x16x32_bf16 v[88:91], v[60:63], v[240:243], v[88:91]
    v_cndmask_b32 v50, v32, v33, s[62:63]
    v_cndmask_b32 v51, v34, v35, s[62:63]
    ds_read_b128 a[132:135], v20 offset:13056
    v_mfma_f32_16x16x32_bf16 v[92:95], v[60:63], v[244:247], v[92:95]
    v_cndmask_b32 v50, v50, v51, s[64:65]
    ds_read_b128 a[136:139], v21 offset:13056
    v_mfma_f32_16x16x32_bf16 v[96:99], v[64:67], v[240:243], v[96:99]
    v_cndmask_b32 v48, v48, v50, vcc
    s_mov_b32 vcc_lo, 0xff00ff00
    ds_read_b128 a[140:143], v112 offset:13056
    v_mfma_f32_16x16x32_bf16 v[100:103], v[64:67], v[244:247], v[100:103]
    s_mov_b32 vcc_hi, 0xff00ff00
    v_cndmask_b32 v50, v36, v37, s[62:63]
    s_waitcnt lgkmcnt(4)
    v_mfma_f32_16x16x32_bf16 v[80:83], v[68:71], v[248:251], v[80:83]
    v_cndmask_b32 v51, v38, v39, s[62:63]
    ds_read_b128 a[144:147], v14 offset:13120
    v_mfma_f32_16x16x32_bf16 v[84:87], v[68:71], v[252:255], v[84:87]
    v_cndmask_b32 v50, v50, v51, s[64:65]
    v_cndmask_b32 v48, v48, v50, vcc
    ds_read_b128 a[148:151], v20 offset:13120
    v_mfma_f32_16x16x32_bf16 v[88:91], v[72:75], v[248:251], v[88:91]
    ds_write_b32 v9, v48
    ds_read_b128 a[152:155], v21 offset:13120
    v_mfma_f32_16x16x32_bf16 v[92:95], v[72:75], v[252:255], v[92:95]
    ds_read_b128 a[156:159], v112 offset:13120
    v_mfma_f32_16x16x32_bf16 v[96:99], v[76:79], v[248:251], v[96:99]
    buffer_load_dword v127, v126, s[28:31], s49 offen sc1
    v_mfma_f32_16x16x32_bf16 v[100:103], v[76:79], v[252:255], v[100:103]
    s_waitcnt lgkmcnt(2)
    s_barrier
    ds_read_b128 v[56:59], v8 offset:0
    ds_read_b128 v[60:63], v8 offset:16
    ds_read_b128 v[64:67], v8 offset:32
    s_waitcnt lgkmcnt(2)
    v_pk_add_f32 v[28:29], v[28:29], v[56:57]
    s_add_u32 m0, s53, 13056
    s_nop 0
    buffer_load_dwordx4 v5, s[16:19], s96 offen offset:0  lds
    v_pk_add_f32 v[30:31], v[30:31], v[58:59]
    s_waitcnt lgkmcnt(1)
    v_pk_add_f32 v[32:33], v[32:33], v[60:61]
    v_pk_add_f32 v[34:35], v[34:35], v[62:63]
    s_waitcnt lgkmcnt(0)
    v_pk_add_f32 v[36:37], v[36:37], v[64:65]
    buffer_load_dwordx4 v5, s[16:19], s97 offen offset:1088  lds
    v_pk_add_f32 v[38:39], v[38:39], v[66:67]
    v_pk_fma_f32 v[80:81], v[114:115], v[28:29], v[80:81] op_sel:[0,0,0] op_sel_hi:[0,1,1]
    v_pk_fma_f32 v[82:83], v[114:115], v[30:31], v[82:83] op_sel:[0,0,0] op_sel_hi:[0,1,1]
    v_pk_fma_f32 v[84:85], v[114:115], v[28:29], v[84:85] op_sel:[1,0,0] op_sel_hi:[1,1,1]
    v_pk_fma_f32 v[86:87], v[114:115], v[30:31], v[86:87] op_sel:[1,0,0] op_sel_hi:[1,1,1]
    buffer_load_dwordx4 v5, s[16:19], s98 offen offset:2176  lds
    v_pk_mul_f32 v[56:57], v[80:81], v[80:81]
    v_pk_mul_f32 v[58:59], v[82:83], v[82:83]
    v_pk_mul_f32 v[60:61], v[84:85], v[84:85]
    v_pk_mul_f32 v[62:63], v[86:87], v[86:87]
    v_pk_fma_f32 v[56:57], v[56:57], v[116:117], v[118:119] op_sel:[0,0,0] op_sel_hi:[1,0,0]
    buffer_load_dwordx4 v5, s[16:19], s99 offen offset:3264  lds
    v_pk_fma_f32 v[58:59], v[58:59], v[116:117], v[118:119] op_sel:[0,0,0] op_sel_hi:[1,0,0]
    v_pk_fma_f32 v[60:61], v[60:61], v[116:117], v[118:119] op_sel:[0,1,1] op_sel_hi:[1,1,1]
    v_pk_fma_f32 v[62:63], v[62:63], v[116:117], v[118:119] op_sel:[0,1,1] op_sel_hi:[1,1,1]
    v_pk_mul_f32 v[56:57], v[56:57], v[80:81]
    v_pk_mul_f32 v[58:59], v[58:59], v[82:83]
    v_xor_b32 v5, 1024, v5
    s_add_u32 m0, s53, 17408
    s_nop 0
    buffer_load_dwordx4 v5, s[16:19], 0 offen offset:0  lds
    v_pk_mul_f32 v[60:61], v[60:61], v[84:85]
    v_pk_mul_f32 v[62:63], v[62:63], v[86:87]
    v_exp_f32 v56, v56
    v_exp_f32 v57, v57
    v_exp_f32 v58, v58
    buffer_load_dwordx4 v5, s[16:19], s93 offen offset:1088  lds
    v_exp_f32 v59, v59
    v_exp_f32 v60, v60
    v_exp_f32 v61, v61
    v_exp_f32 v62, v62
    v_exp_f32 v63, v63
    buffer_load_dwordx4 v5, s[16:19], s94 offen offset:2176  lds
    v_pk_fma_f32 v[56:57], v[56:57], v[120:121], v[120:121] op_sel:[0,0,0] op_sel_hi:[1,0,0]
    v_pk_fma_f32 v[58:59], v[58:59], v[120:121], v[120:121] op_sel:[0,0,0] op_sel_hi:[1,0,0]
    v_pk_fma_f32 v[60:61], v[60:61], v[120:121], v[120:121] op_sel:[0,1,1] op_sel_hi:[1,1,1]
    v_pk_fma_f32 v[62:63], v[62:63], v[120:121], v[120:121] op_sel:[0,1,1] op_sel_hi:[1,1,1]
    buffer_load_dwordx4 v5, s[16:19], s95 offen offset:3264  lds
    v_rcp_f32 v56, v56
    v_rcp_f32 v57, v57
    v_rcp_f32 v58, v58
    v_rcp_f32 v59, v59
    v_rcp_f32 v60, v60
    s_waitcnt vmcnt(13)
    ds_read_b128 a[160:163], v14 offset:0
    v_rcp_f32 v61, v61
    v_rcp_f32 v62, v62
    v_rcp_f32 v63, v63
    v_pk_mul_f32 v[80:81], v[80:81], v[56:57]
    v_pk_mul_f32 v[82:83], v[82:83], v[58:59]
    ds_read_b128 a[164:167], v20 offset:0
    v_pk_mul_f32 v[84:85], v[84:85], v[60:61]
    v_pk_mul_f32 v[86:87], v[86:87], v[62:63]
    v_pk_fma_f32 v[88:89], v[114:115], v[32:33], v[88:89] op_sel:[0,0,0] op_sel_hi:[0,1,1]
    v_pk_fma_f32 v[90:91], v[114:115], v[34:35], v[90:91] op_sel:[0,0,0] op_sel_hi:[0,1,1]
    v_pk_fma_f32 v[92:93], v[114:115], v[32:33], v[92:93] op_sel:[1,0,0] op_sel_hi:[1,1,1]
    ds_read_b128 a[168:171], v21 offset:0
    v_pk_fma_f32 v[94:95], v[114:115], v[34:35], v[94:95] op_sel:[1,0,0] op_sel_hi:[1,1,1]
    v_pk_mul_f32 v[56:57], v[88:89], v[88:89]
    v_pk_mul_f32 v[58:59], v[90:91], v[90:91]
    v_pk_mul_f32 v[60:61], v[92:93], v[92:93]
    v_pk_mul_f32 v[62:63], v[94:95], v[94:95]
    ds_read_b128 a[172:175], v112 offset:0
    v_pk_fma_f32 v[56:57], v[56:57], v[116:117], v[118:119] op_sel:[0,0,0] op_sel_hi:[1,0,0]
    v_pk_fma_f32 v[58:59], v[58:59], v[116:117], v[118:119] op_sel:[0,0,0] op_sel_hi:[1,0,0]
    v_pk_fma_f32 v[60:61], v[60:61], v[116:117], v[118:119] op_sel:[0,1,1] op_sel_hi:[1,1,1]
    v_pk_fma_f32 v[62:63], v[62:63], v[116:117], v[118:119] op_sel:[0,1,1] op_sel_hi:[1,1,1]
    v_pk_mul_f32 v[56:57], v[56:57], v[88:89]
    ds_read_b128 a[176:179], v14 offset:64
    v_pk_mul_f32 v[58:59], v[58:59], v[90:91]
    v_pk_mul_f32 v[60:61], v[60:61], v[92:93]
    v_pk_mul_f32 v[62:63], v[62:63], v[94:95]
    v_exp_f32 v56, v56
    v_exp_f32 v57, v57
    ds_read_b128 a[180:183], v20 offset:64
    v_exp_f32 v58, v58
    v_exp_f32 v59, v59
    v_exp_f32 v60, v60
    v_exp_f32 v61, v61
    ds_read_b128 a[184:187], v21 offset:64
    v_exp_f32 v62, v62
    v_exp_f32 v63, v63
    v_pk_fma_f32 v[56:57], v[56:57], v[120:121], v[120:121] op_sel:[0,0,0] op_sel_hi:[1,0,0]
    v_pk_fma_f32 v[58:59], v[58:59], v[120:121], v[120:121] op_sel:[0,0,0] op_sel_hi:[1,0,0]
    v_pk_fma_f32 v[60:61], v[60:61], v[120:121], v[120:121] op_sel:[0,1,1] op_sel_hi:[1,1,1]
    ds_read_b128 a[188:191], v112 offset:64
    v_pk_fma_f32 v[62:63], v[62:63], v[120:121], v[120:121] op_sel:[0,1,1] op_sel_hi:[1,1,1]
    v_rcp_f32 v56, v56
    v_rcp_f32 v57, v57
    v_rcp_f32 v58, v58
    v_rcp_f32 v59, v59
    s_add_u32 m0, s53, 0
    s_waitcnt lgkmcnt(0)
    buffer_load_dwordx4 v5, s[16:19], s96 offen offset:0  lds
    v_rcp_f32 v60, v60
    v_rcp_f32 v61, v61
    v_rcp_f32 v62, v62
    v_rcp_f32 v63, v63
    v_pk_mul_f32 v[88:89], v[88:89], v[56:57]
    buffer_load_dwordx4 v5, s[16:19], s97 offen offset:1088  lds
    v_pk_mul_f32 v[90:91], v[90:91], v[58:59]
    v_pk_mul_f32 v[92:93], v[92:93], v[60:61]
    v_pk_mul_f32 v[94:95], v[94:95], v[62:63]
    v_pk_fma_f32 v[96:97], v[114:115], v[36:37], v[96:97] op_sel:[0,0,0] op_sel_hi:[0,1,1]
    v_pk_fma_f32 v[98:99], v[114:115], v[38:39], v[98:99] op_sel:[0,0,0] op_sel_hi:[0,1,1]
    buffer_load_dwordx4 v5, s[16:19], s98 offen offset:2176  lds
    v_pk_fma_f32 v[100:101], v[114:115], v[36:37], v[100:101] op_sel:[1,0,0] op_sel_hi:[1,1,1]
    v_pk_fma_f32 v[102:103], v[114:115], v[38:39], v[102:103] op_sel:[1,0,0] op_sel_hi:[1,1,1]
    v_pk_mul_f32 v[56:57], v[96:97], v[96:97]
    v_pk_mul_f32 v[58:59], v[98:99], v[98:99]
    v_pk_mul_f32 v[60:61], v[100:101], v[100:101]
    buffer_load_dwordx4 v5, s[16:19], s99 offen offset:3264  lds
    v_pk_mul_f32 v[62:63], v[102:103], v[102:103]
    v_pk_fma_f32 v[56:57], v[56:57], v[116:117], v[118:119] op_sel:[0,0,0] op_sel_hi:[1,0,0]
    v_pk_fma_f32 v[58:59], v[58:59], v[116:117], v[118:119] op_sel:[0,0,0] op_sel_hi:[1,0,0]
    v_pk_fma_f32 v[60:61], v[60:61], v[116:117], v[118:119] op_sel:[0,1,1] op_sel_hi:[1,1,1]
    v_and_b32 v124, 31, v1
    v_lshl_add_u32 v124, v124, 6, s55
    v_lshlrev_b32 v124, 1, v124
    buffer_load_ushort v124, v124, s[32:35], 0 offen
    v_pk_fma_f32 v[62:63], v[62:63], v[116:117], v[118:119] op_sel:[0,1,1] op_sel_hi:[1,1,1]
    v_pk_mul_f32 v[56:57], v[56:57], v[96:97]
    v_pk_mul_f32 v[58:59], v[58:59], v[98:99]
    v_pk_mul_f32 v[60:61], v[60:61], v[100:101]
    v_pk_mul_f32 v[62:63], v[62:63], v[102:103]
    s_waitcnt vmcnt(13)
    v_cmp_ne_u32 vcc, s43, v127
    s_cbranch_vccnz L_ss2
L_bs2:
    s_barrier
    v_exp_f32 v56, v56
    v_exp_f32 v57, v57
    v_exp_f32 v58, v58
    v_exp_f32 v59, v59
    v_exp_f32 v60, v60
    s_add_u32 m0, s54, 0
    s_mov_b32 s4, 1048576
    buffer_load_dwordx4 v125, s[28:31], s4 offen offset:0 sc1 lds
    v_exp_f32 v61, v61
    v_exp_f32 v62, v62
    v_exp_f32 v63, v63
    v_pk_fma_f32 v[56:57], v[56:57], v[120:121], v[120:121] op_sel:[0,0,0] op_sel_hi:[1,0,0]
    v_pk_fma_f32 v[58:59], v[58:59], v[120:121], v[120:121] op_sel:[0,0,0] op_sel_hi:[1,0,0]
    buffer_load_dwordx4 v125, s[28:31], s4 offen offset:1024 sc1 lds
    v_pk_fma_f32 v[60:61], v[60:61], v[120:121], v[120:121] op_sel:[0,1,1] op_sel_hi:[1,1,1]
    v_pk_fma_f32 v[62:63], v[62:63], v[120:121], v[120:121] op_sel:[0,1,1] op_sel_hi:[1,1,1]
    v_rcp_f32 v56, v56
    v_rcp_f32 v57, v57
    v_rcp_f32 v58, v58
    buffer_load_dwordx4 v125, s[28:31], s4 offen offset:2048 sc1 lds
    v_rcp_f32 v59, v59
    v_rcp_f32 v60, v60
    v_rcp_f32 v61, v61
    v_rcp_f32 v62, v62
    v_rcp_f32 v63, v63
    buffer_load_dwordx4 v125, s[28:31], s4 offen offset:3072 sc1 lds
    v_pk_mul_f32 v[96:97], v[96:97], v[56:57]
    v_pk_mul_f32 v[98:99], v[98:99], v[58:59]
    v_pk_mul_f32 v[100:101], v[100:101], v[60:61]
    v_pk_mul_f32 v[102:103], v[102:103], v[62:63]
    v_cvt_pk_bf16_f32 v128, v80, v81
    s_waitcnt vmcnt(13)
    ds_read_b128 a[192:195], v14 offset:8704
    v_cvt_pk_bf16_f32 v129, v82, v83
    v_cvt_pk_bf16_f32 v130, v84, v85
    ds_read_b128 a[196:199], v20 offset:8704
    v_cvt_pk_bf16_f32 v131, v86, v87
    v_cvt_pk_bf16_f32 v132, v88, v89
    ds_read_b128 a[200:203], v21 offset:8704
    v_cvt_pk_bf16_f32 v133, v90, v91
    v_cvt_pk_bf16_f32 v134, v92, v93
    ds_read_b128 a[204:207], v112 offset:8704
    v_cvt_pk_bf16_f32 v135, v94, v95
    v_cvt_pk_bf16_f32 v136, v96, v97
    v_cvt_pk_bf16_f32 v137, v98, v99
    ds_read_b128 a[208:211], v14 offset:8768
    v_cvt_pk_bf16_f32 v138, v100, v101
    v_cvt_pk_bf16_f32 v139, v102, v103
    ds_read_b128 a[212:215], v20 offset:8768
    v_permlane16_swap_b32 v128, v130
    v_permlane16_swap_b32 v129, v131
    ds_read_b128 a[216:219], v21 offset:8768
    v_permlane16_swap_b32 v132, v134
    v_permlane16_swap_b32 v133, v135
    ds_read_b128 a[220:223], v112 offset:8768
    v_permlane16_swap_b32 v136, v138
    v_permlane16_swap_b32 v137, v139
    s_add_u32 m0, s54, 16384
    s_mov_b32 s4, 1052672
    buffer_load_dwordx4 v125, s[28:31], s4 offen offset:0 sc1 lds
    v_and_b32 v6, 1, v3
    buffer_load_dwordx4 v125, s[28:31], s4 offen offset:1024 sc1 lds
    v_xor_b32 v6, s40, v6
    v_and_b32 v7, 1, v1
    v_lshl_add_u32 v6, v6, 1, v7
    v_mul_u32_u24 v6, 1056, v6
    v_lshrrev_b32 v7, 2, v2
    v_lshl_add_u32 v6, v7, 7, v6
    buffer_load_dwordx4 v125, s[28:31], s4 offen offset:2048 sc1 lds
    v_lshrrev_b32 v7, 3, v2
    v_lshrrev_b32 v8, 1, v3
    v_xor_b32 v7, v7, v8
    v_lshl_add_u32 v6, v7, 4, v6
    v_bfe_u32 v7, v1, 1, 1
    v_lshl_add_u32 v6, v7, 3, v6
    s_bfe_u32 s47, s45, 0x70003
    buffer_load_dwordx4 v125, s[28:31], s4 offen offset:3072 sc1 lds
    v_xor_b32 v6, s47, v6
    v_lshl_add_u32 v5, s40, 13, v6
    v_xor_b32 v14, 32, v5
    v_xor_b32 v15, 64, v5
    v_xor_b32 v16, 96, v5
    v_add_u32 v17, 65536, v5
    v_add_u32 v19, 65536, v14
    s_add_u32 m0, s54, 32768
    s_mov_b32 s4, 1056768
    buffer_load_dwordx4 v125, s[28:31], s4 offen offset:0 sc1 lds
    v_add_u32 v20, 65536, v15
    v_add_u32 v21, 65536, v16
    s_lshl_b32 s47, s38, 11
    s_add_u32 s47, s47, 114688
    v_mad_u32_u24 v23, v1, 16, s47
    v_xor_b32 v22, 2048, v23
    v_and_b32 v6, 1, v3
    buffer_load_dwordx4 v125, s[28:31], s4 offen offset:1024 sc1 lds
    v_lshlrev_b32 v6, 13, v6
    v_lshl_add_u32 v6, v2, 4, v6
    v_lshrrev_b32 v7, 1, v3
    v_lshl_add_u32 v6, v7, 8, v6
    s_mul_i32 s47, s36, 98304
    s_lshl_b32 s48, s39, 14
    s_add_u32 s47, s47, s48
    buffer_load_dwordx4 v125, s[28:31], s4 offen offset:2048 sc1 lds
    s_lshl_b32 s48, s40, 9
    s_add_u32 s47, s47, s48
    s_lshl_b32 s48, s37, 10
    s_add_u32 s48, s48, s47
    v_add_u32 v24, s48, v6
    s_mul_i32 s48, s37, 768
    s_min_u32 s48, s48, 5120
    buffer_load_dwordx4 v125, s[28:31], s4 offen offset:3072 sc1 lds
    s_add_u32 s48, s48, s47
    v_add_u32 v6, s48, v6
    v_mov_b32 v7, 2146435072
    v_cndmask_b32 v25, v7, v6, s[60:61]
    v_lshrrev_b32 v6, 3, v1
    v_and_b32 v7, 2, v6
    v_and_b32 v8, 7, v1
    s_waitcnt vmcnt(13)
    ds_read_b128 a[224:227], v10 offset:17408
    ds_read_b128 a[228:231], v11 offset:17408
    s_lshl_b32 s47, s40, 2
    v_bitop3_b32 v7, v7, v8, s47 bitop3:0x96
    v_lshlrev_b32 v7, 4, v7
    v_lshl_add_u32 v7, v6, 10, v7
    s_lshl_b32 s47, s38, 6
    s_add_u32 s47, s47, s37
    s_lshl_b32 s47, s47, 7
    ds_read_b128 a[232:235], v12 offset:17408
    ds_read_b128 a[236:239], v13 offset:17408
    v_add_u32 v102, s47, v7
    v_lshlrev_b32 v6, 12, v3
    v_lshrrev_b32 v7, 2, v2
    v_lshl_add_u32 v6, v7, 7, v6
    v_and_b32 v7, 3, v1
    v_lshl_add_u32 v6, v7, 3, v6
    v_lshrrev_b32 v7, 3, v2
    ds_read_b128 a[240:243], v10 offset:17472
    ds_read_b128 a[244:247], v11 offset:17472
    v_lshl_add_u32 v6, v7, 5, v6
    v_and_b32 v7, 1, v3
    v_lshl_add_u32 v6, v7, 6, v6
    v_add_u32 v148, 32768, v6
    v_xor_b32 v149, 32, v148
    v_xor_b32 v150, 64, v148
    ds_read_b128 a[248:251], v12 offset:17472
    ds_read_b128 a[252:255], v13 offset:17472
    v_xor_b32 v151, 96, v148
    v_add_u32 v103, 65536, v148
    v_add_u32 v112, 65536, v149
    v_add_u32 v122, 65536, v150
    v_add_u32 v123, 65536, v151
    s_cmp_ge_u32 s37, 4
    s_cselect_b32 s45, -1, 0
    s_and_b32 s47, s45, 0x80000000
    s_add_u32 m0, s54, 49152
    s_mov_b32 s4, 1060864
    buffer_load_dwordx4 v125, s[28:31], s4 offen offset:0 sc1 lds
    s_or_b32 s47, s47, 0x3a000000
    s_lshl_b32 s48, s40, 10
    s_add_u32 s48, s48, s55
    v_lshl_add_u32 v6, v2, 6, s48
    v_cvt_f32_u32 v6, v6
    v_mul_f32 v6, s47, v6
    v_lshlrev_b32 v7, 2, v3
    buffer_load_dwordx4 v125, s[28:31], s4 offen offset:1024 sc1 lds
    v_cvt_f32_u32 v7, v7
    v_mul_f32 v7, v7, v6
    v_mul_f32 v184, 0x41800000, v6
    v_fmamk_f32 v168, v6, 0x00000000, v7
    v_fmamk_f32 v170, v6, 0x3f800000, v7
    v_fmamk_f32 v172, v6, 0x40000000, v7
    v_fmamk_f32 v174, v6, 0x40400000, v7
    buffer_load_dwordx4 v125, s[28:31], s4 offen offset:2048 sc1 lds
    v_sin_f32 v185, v184
    v_cos_f32 v184, v184
    v_sin_f32 v169, v168
    v_cos_f32 v168, v168
    v_sin_f32 v171, v170
    v_cos_f32 v170, v170
    v_sin_f32 v173, v172
    buffer_load_dwordx4 v125, s[28:31], s4 offen offset:3072 sc1 lds
    v_cos_f32 v172, v172
    v_sin_f32 v175, v174
    v_cos_f32 v174, v174
    v_pk_mul_f32 v[176:177], v[168:169], v[184:185] op_sel:[1,1] op_sel_hi:[0,1]
    v_pk_mul_f32 v[178:179], v[170:171], v[184:185] op_sel:[1,1] op_sel_hi:[0,1]
    v_pk_mul_f32 v[180:181], v[172:173], v[184:185] op_sel:[1,1] op_sel_hi:[0,1]
    v_pk_mul_f32 v[182:183], v[174:175], v[184:185] op_sel:[1,1] op_sel_hi:[0,1]
    s_waitcnt lgkmcnt(0)
    s_barrier
    s_add_u32 m0, s54, 65536
    s_mov_b32 s4, 1064960
    buffer_load_dwordx4 v125, s[28:31], s4 offen offset:0 sc1 lds
    v_cvt_pk_bf16_f32 v152, v168, v169
    v_cvt_pk_bf16_f32 v153, v170, v171
    v_cvt_pk_bf16_f32 v154, v172, v173
    v_cvt_pk_bf16_f32 v155, v174, v175
    v_pk_fma_f32 v[176:177], v[168:169], v[184:185], v[176:177] op_sel_hi:[1,0,1] neg_lo:[0,0,1]
    v_pk_fma_f32 v[178:179], v[170:171], v[184:185], v[178:179] op_sel_hi:[1,0,1] neg_lo:[0,0,1]
    v_pk_fma_f32 v[180:181], v[172:173], v[184:185], v[180:181] op_sel_hi:[1,0,1] neg_lo:[0,0,1]
    buffer_load_dwordx4 v125, s[28:31], s4 offen offset:1024 sc1 lds
    v_pk_fma_f32 v[182:183], v[174:175], v[184:185], v[182:183] op_sel_hi:[1,0,1] neg_lo:[0,0,1]
    v_pk_mul_f32 v[168:169], v[176:177], v[184:185] op_sel:[1,1] op_sel_hi:[0,1]
    v_pk_mul_f32 v[170:171], v[178:179], v[184:185] op_sel:[1,1] op_sel_hi:[0,1]
    v_pk_mul_f32 v[172:173], v[180:181], v[184:185] op_sel:[1,1] op_sel_hi:[0,1]
    v_pk_mul_f32 v[174:175], v[182:183], v[184:185] op_sel:[1,1] op_sel_hi:[0,1]
    v_cvt_pk_bf16_f32 v156, v176, v177
    v_cvt_pk_bf16_f32 v157, v178, v179
    buffer_load_dwordx4 v125, s[28:31], s4 offen offset:2048 sc1 lds
    v_cvt_pk_bf16_f32 v158, v180, v181
    v_cvt_pk_bf16_f32 v159, v182, v183
    v_pk_fma_f32 v[168:169], v[176:177], v[184:185], v[168:169] op_sel_hi:[1,0,1] neg_lo:[0,0,1]
    v_pk_fma_f32 v[170:171], v[178:179], v[184:185], v[170:171] op_sel_hi:[1,0,1] neg_lo:[0,0,1]
    v_pk_fma_f32 v[172:173], v[180:181], v[184:185], v[172:173] op_sel_hi:[1,0,1] neg_lo:[0,0,1]
    v_pk_fma_f32 v[174:175], v[182:183], v[184:185], v[174:175] op_sel_hi:[1,0,1] neg_lo:[0,0,1]
    v_pk_mul_f32 v[176:177], v[168:169], v[184:185] op_sel:[1,1] op_sel_hi:[0,1]
    buffer_load_dwordx4 v125, s[28:31], s4 offen offset:3072 sc1 lds
    v_pk_mul_f32 v[178:179], v[170:171], v[184:185] op_sel:[1,1] op_sel_hi:[0,1]
    v_pk_mul_f32 v[180:181], v[172:173], v[184:185] op_sel:[1,1] op_sel_hi:[0,1]
    v_pk_mul_f32 v[182:183], v[174:175], v[184:185] op_sel:[1,1] op_sel_hi:[0,1]
    v_cvt_pk_bf16_f32 v160, v168, v169
    v_cvt_pk_bf16_f32 v161, v170, v171
    v_cvt_pk_bf16_f32 v162, v172, v173
    s_add_u32 m0, s54, 81920
    s_mov_b32 s4, 1069056
    buffer_load_dwordx4 v125, s[28:31], s4 offen offset:0 sc1 lds
    v_cvt_pk_bf16_f32 v163, v174, v175
    v_pk_fma_f32 v[176:177], v[168:169], v[184:185], v[176:177] op_sel_hi:[1,0,1] neg_lo:[0,0,1]
    v_pk_fma_f32 v[178:179], v[170:171], v[184:185], v[178:179] op_sel_hi:[1,0,1] neg_lo:[0,0,1]
    v_pk_fma_f32 v[180:181], v[172:173], v[184:185], v[180:181] op_sel_hi:[1,0,1] neg_lo:[0,0,1]
    v_pk_fma_f32 v[182:183], v[174:175], v[184:185], v[182:183] op_sel_hi:[1,0,1] neg_lo:[0,0,1]
    v_cvt_pk_bf16_f32 v164, v176, v177
    v_cvt_pk_bf16_f32 v165, v178, v179
    buffer_load_dwordx4 v125, s[28:31], s4 offen offset:1024 sc1 lds
    v_cvt_pk_bf16_f32 v166, v180, v181
    v_cvt_pk_bf16_f32 v167, v182, v183
    s_sub_u32 s58, 11, s42
    s_lshl_b32 s58, s58, 10
    s_xor_b32 s47, s36, s45
    s_sub_u32 s47, s47, s45
    s_and_b32 s47, s47, 31
    buffer_load_dwordx4 v125, s[28:31], s4 offen offset:2048 sc1 lds
    s_mul_i32 s46, s47, 65792
    s_add_u32 s46, s46, 4194304
    s_xor_b32 s53, s37, s45
    s_and_b32 s53, s53, 3
    v_and_b32 v10, 1, v3
    v_lshlrev_b32 v10, 5, v10
    v_lshlrev_b32 v11, 10, v3
    buffer_load_dwordx4 v125, s[28:31], s4 offen offset:3072 sc1 lds
    v_add_u32 v11, 65536, v11
    v_add_u32 v6, 0, v2
    v_xor_b32 v6, s45, v6
    v_subrev_u32 v6, s45, v6
    v_and_b32 v7, 0x12, v6
    v_lshl_add_u32 v7, v7, 3, v11
    v_and_b32 v8, 1, v6
    s_add_u32 m0, s54, 98304
    s_mov_b32 s4, 1073152
    buffer_load_dwordx4 v125, s[28:31], s4 offen offset:0 sc1 lds
    v_lshl_add_u32 v7, v8, 6, v7
    v_bitop3_b32 v8, v6, 44, v10 bitop3:0x6a
    v_add_u32 v248, v7, v8
    v_add_u32 v6, 16, v2
    v_xor_b32 v6, s45, v6
    v_subrev_u32 v6, s45, v6
    v_and_b32 v7, 0x12, v6
    buffer_load_dwordx4 v125, s[28:31], s4 offen offset:1024 sc1 lds
    v_lshl_add_u32 v7, v7, 3, v11
    v_and_b32 v8, 1, v6
    v_lshl_add_u32 v7, v8, 6, v7
    v_bitop3_b32 v8, v6, 44, v10 bitop3:0x6a
    v_add_u32 v249, v7, v8
    v_add_u32 v6, 32, v2
    v_xor_b32 v6, s45, v6
    buffer_load_dwordx4 v125, s[28:31], s4 offen offset:2048 sc1 lds
    v_subrev_u32 v6, s45, v6
    v_and_b32 v7, 0x12, v6
    v_lshl_add_u32 v7, v7, 3, v11
    v_and_b32 v8, 1, v6
    v_lshl_add_u32 v7, v8, 6, v7
    v_bitop3_b32 v8, v6, 44, v10 bitop3:0x6a
    v_add_u32 v250, v7, v8
    buffer_load_dwordx4 v125, s[28:31], s4 offen offset:3072 sc1 lds
    v_add_u32 v6, 48, v2
    v_xor_b32 v6, s45, v6
    v_subrev_u32 v6, s45, v6
    v_and_b32 v7, 0x12, v6
    v_lshl_add_u32 v7, v7, 3, v11
    v_and_b32 v8, 1, v6
    v_lshl_add_u32 v7, v8, 6, v7
    v_bitop3_b32 v8, v6, 44, v10 bitop3:0x6a
    v_add_u32 v251, v7, v8
    v_bfe_u32 v6, v2, 2, 1
    v_lshlrev_b32 v6, 5, v6
    v_lshl_add_u32 v6, v2, 8, v6
    v_add_u32 v252, s54, v6
    s_mul_i32 s47, s36, 12
    s_add_u32 s47, s47, s38
    s_lshl_b32 s47, s47, 13
    v_add_u32 v254, s47, v4
    v_cmp_gt_u32 vcc, 32, v1
    v_mov_b32 v7, 2146435072
    v_lshlrev_b32 v6, 7, v1
    v_cndmask_b32 v255, v7, v254, vcc
    v_cndmask_b32 v126, v7, v6, vcc
    v_bfe_u32 v6, v1, 3, 1
    v_xor_b32 v6, v6, v1
    v_lshlrev_b32 v7, 3, v1
    v_bfi_b32 v6, 8, v7, v6
    v_lshlrev_b32 v126, 4, v6
    s_waitcnt vmcnt(24)
    s_barrier
    ds_read_b64_tr_b16 v[58:59], v5 offset:0
    ds_read_b64_tr_b16 v[60:61], v5 offset:512
    ds_read_b64_tr_b16 v[62:63], v5 offset:4096
    ds_read_b64_tr_b16 v[64:65], v5 offset:4608
    ds_read_b64_tr_b16 v[66:67], v14 offset:0
    ds_read_b64_tr_b16 v[68:69], v14 offset:512
    ds_read_b64_tr_b16 v[70:71], v14 offset:4096
    ds_read_b64_tr_b16 v[72:73], v14 offset:4608
    ds_read_b64_tr_b16 v[74:75], v15 offset:0
    ds_read_b64_tr_b16 v[76:77], v15 offset:512
    ds_read_b64_tr_b16 v[78:79], v15 offset:4096
    ds_read_b64_tr_b16 v[80:81], v15 offset:4608
    s_waitcnt lgkmcnt(4)
    v_mfma_f32_32x32x16_bf16 v[26:41], v[58:61], a[0:3], 0
    s_add_u32 m0, s54, 131072
    s_mov_b32 s50, 0
    buffer_load_dwordx4 v102, s[20:23], s50 offen  lds
    ds_read_b64_tr_b16 v[82:83], v16 offset:0
    v_mfma_f32_32x32x16_bf16 v[26:41], v[62:65], a[32:35], v[26:41]
    ds_read_b64_tr_b16 v[84:85], v16 offset:512
    ds_read_b64_tr_b16 v[86:87], v16 offset:4096
    ds_read_b64_tr_b16 v[88:89], v16 offset:4608
    v_mfma_f32_32x32x16_bf16 v[26:41], v[66:69], a[64:67], v[26:41]
    s_add_u32 m0, s54, 132096
    s_mov_b32 s50, 90112
    buffer_load_dwordx4 v102, s[20:23], s50 offen  lds
    s_waitcnt vmcnt(22)
    s_barrier
    ds_read_b64_tr_b16 v[58:59], v5 offset:16384
    v_mfma_f32_32x32x16_bf16 v[26:41], v[70:73], a[96:99], v[26:41]
    ds_read_b64_tr_b16 v[60:61], v5 offset:16896
    ds_read_b64_tr_b16 v[62:63], v5 offset:20480
    ds_read_b64_tr_b16 v[64:65], v5 offset:20992
    v_lshlrev_b32 v232, 16, v104
    s_waitcnt lgkmcnt(4)
    v_mfma_f32_32x32x16_bf16 v[26:41], v[74:77], a[128:131], v[26:41]
    s_add_u32 m0, s54, 133120
    s_mov_b32 s50, 180224
    buffer_load_dwordx4 v102, s[20:23], s50 offen  lds
    ds_read_b64_tr_b16 v[66:67], v14 offset:16384
    v_and_b32 v233, 0xffff0000, v104
    v_mfma_f32_32x32x16_bf16 v[26:41], v[78:81], a[160:163], v[26:41]
    ds_read_b64_tr_b16 v[68:69], v14 offset:16896
    ds_read_b64_tr_b16 v[70:71], v14 offset:20480
    ds_read_b64_tr_b16 v[72:73], v14 offset:20992
    v_mfma_f32_32x32x16_bf16 v[26:41], v[82:85], a[192:195], v[26:41]
    s_add_u32 m0, s54, 134144
    s_mov_b32 s50, 270336
    buffer_load_dwordx4 v102, s[20:23], s50 offen  lds
    ds_read_b64_tr_b16 v[74:75], v15 offset:16384
    v_lshlrev_b32 v234, 16, v105
    v_mfma_f32_32x32x16_bf16 v[26:41], v[86:89], a[224:227], v[26:41]
    ds_read_b64_tr_b16 v[76:77], v15 offset:16896
    ds_read_b64_tr_b16 v[78:79], v15 offset:20480
    ds_read_b64_tr_b16 v[80:81], v15 offset:20992
    v_and_b32 v235, 0xffff0000, v105
    s_waitcnt lgkmcnt(4)
    v_mfma_f32_32x32x16_bf16 v[26:41], v[58:61], a[4:7], v[26:41]
    s_add_u32 m0, s54, 147456
    s_mov_b32 s50, 360448
    buffer_load_dwordx4 v102, s[20:23], s50 offen  lds
    ds_read_b64_tr_b16 v[82:83], v16 offset:16384
    v_mfma_f32_32x32x16_bf16 v[26:41], v[62:65], a[36:39], v[26:41]
    ds_read_b64_tr_b16 v[84:85], v16 offset:16896
    ds_read_b64_tr_b16 v[86:87], v16 offset:20480
    ds_read_b64_tr_b16 v[88:89], v16 offset:20992
    v_lshlrev_b32 v236, 16, v106
    v_mfma_f32_32x32x16_bf16 v[26:41], v[66:69], a[68:71], v[26:41]
    s_add_u32 m0, s54, 148480
    s_mov_b32 s50, 450560
    buffer_load_dwordx4 v102, s[20:23], s50 offen  lds
    s_waitcnt vmcnt(22)
    s_barrier
    ds_read_b64_tr_b16 v[58:59], v5 offset:32768
    v_mfma_f32_32x32x16_bf16 v[26:41], v[70:73], a[100:103], v[26:41]
    ds_read_b64_tr_b16 v[60:61], v5 offset:33280
    ds_read_b64_tr_b16 v[62:63], v5 offset:36864
    ds_read_b64_tr_b16 v[64:65], v5 offset:37376
    v_and_b32 v237, 0xffff0000, v106
    s_waitcnt lgkmcnt(4)
    v_mfma_f32_32x32x16_bf16 v[26:41], v[74:77], a[132:135], v[26:41]
    s_add_u32 m0, s54, 149504
    s_mov_b32 s50, 540672
    buffer_load_dwordx4 v102, s[20:23], s50 offen  lds
    ds_read_b64_tr_b16 v[66:67], v14 offset:32768
    v_lshlrev_b32 v238, 16, v107
    v_mfma_f32_32x32x16_bf16 v[26:41], v[78:81], a[164:167], v[26:41]
    ds_read_b64_tr_b16 v[68:69], v14 offset:33280
    ds_read_b64_tr_b16 v[70:71], v14 offset:36864
    ds_read_b64_tr_b16 v[72:73], v14 offset:37376
    v_mfma_f32_32x32x16_bf16 v[26:41], v[82:85], a[196:199], v[26:41]
    s_add_u32 m0, s54, 150528
    s_mov_b32 s50, 622592
    buffer_load_dwordx4 v102, s[20:23], s50 offen  lds
    ds_read_b64_tr_b16 v[74:75], v15 offset:32768
    v_and_b32 v239, 0xffff0000, v107
    v_mfma_f32_32x32x16_bf16 v[26:41], v[86:89], a[228:231], v[26:41]
    ds_read_b64_tr_b16 v[76:77], v15 offset:33280
    ds_read_b64_tr_b16 v[78:79], v15 offset:36864
    ds_read_b64_tr_b16 v[80:81], v15 offset:37376
    v_lshlrev_b32 v240, 16, v108
    s_waitcnt lgkmcnt(4)
    v_mfma_f32_32x32x16_bf16 v[26:41], v[58:61], a[8:11], v[26:41]
    s_add_u32 m0, s54, 0
    s_mov_b32 s4, 1077248
    buffer_load_dwordx4 v125, s[28:31], s4 offen offset:0 sc1 lds
    ds_read_b64_tr_b16 v[82:83], v16 offset:32768
    v_mfma_f32_32x32x16_bf16 v[26:41], v[62:65], a[40:43], v[26:41]
    ds_read_b64_tr_b16 v[84:85], v16 offset:33280
    ds_read_b64_tr_b16 v[86:87], v16 offset:36864
    ds_read_b64_tr_b16 v[88:89], v16 offset:37376
    v_and_b32 v241, 0xffff0000, v108
    v_mfma_f32_32x32x16_bf16 v[26:41], v[66:69], a[72:75], v[26:41]
    buffer_load_dwordx4 v125, s[28:31], s4 offen offset:1024 sc1 lds
    s_waitcnt vmcnt(22)
    s_barrier
    ds_read_b64_tr_b16 v[58:59], v5 offset:49152
    v_mfma_f32_32x32x16_bf16 v[26:41], v[70:73], a[104:107], v[26:41]
    ds_read_b64_tr_b16 v[60:61], v5 offset:49664
    ds_read_b64_tr_b16 v[62:63], v5 offset:53248
    ds_read_b64_tr_b16 v[64:65], v5 offset:53760
    v_lshlrev_b32 v242, 16, v109
    s_waitcnt lgkmcnt(4)
    v_mfma_f32_32x32x16_bf16 v[26:41], v[74:77], a[136:139], v[26:41]
    buffer_load_dwordx4 v125, s[28:31], s4 offen offset:2048 sc1 lds
    ds_read_b64_tr_b16 v[66:67], v14 offset:49152
    v_and_b32 v243, 0xffff0000, v109
    v_mfma_f32_32x32x16_bf16 v[26:41], v[78:81], a[168:171], v[26:41]
    ds_read_b64_tr_b16 v[68:69], v14 offset:49664
    ds_read_b64_tr_b16 v[70:71], v14 offset:53248
    ds_read_b64_tr_b16 v[72:73], v14 offset:53760
    v_mfma_f32_32x32x16_bf16 v[26:41], v[82:85], a[200:203], v[26:41]
    buffer_load_dwordx4 v125, s[28:31], s4 offen offset:3072 sc1 lds
    ds_read_b64_tr_b16 v[74:75], v15 offset:49152
    v_lshlrev_b32 v244, 16, v110
    v_mfma_f32_32x32x16_bf16 v[26:41], v[86:89], a[232:235], v[26:41]
    ds_read_b64_tr_b16 v[76:77], v15 offset:49664
    ds_read_b64_tr_b16 v[78:79], v15 offset:53248
    ds_read_b64_tr_b16 v[80:81], v15 offset:53760
    v_and_b32 v245, 0xffff0000, v110
    s_waitcnt lgkmcnt(4)
    v_mfma_f32_32x32x16_bf16 v[26:41], v[58:61], a[12:15], v[26:41]
    s_add_u32 m0, s54, 16384
    s_mov_b32 s4, 1081344
    buffer_load_dwordx4 v125, s[28:31], s4 offen offset:0 sc1 lds
    ds_read_b64_tr_b16 v[82:83], v16 offset:49152
    v_mfma_f32_32x32x16_bf16 v[26:41], v[62:65], a[44:47], v[26:41]
    ds_read_b64_tr_b16 v[84:85], v16 offset:49664
    ds_read_b64_tr_b16 v[86:87], v16 offset:53248
    ds_read_b64_tr_b16 v[88:89], v16 offset:53760
    v_lshlrev_b32 v246, 16, v111
    v_mfma_f32_32x32x16_bf16 v[26:41], v[66:69], a[76:79], v[26:41]
    buffer_load_dwordx4 v125, s[28:31], s4 offen offset:1024 sc1 lds
    s_waitcnt vmcnt(22)
    s_barrier
    ds_read_b64_tr_b16 v[58:59], v17 offset:0
    v_mfma_f32_32x32x16_bf16 v[26:41], v[70:73], a[108:111], v[26:41]
    ds_read_b64_tr_b16 v[60:61], v17 offset:512
    ds_read_b64_tr_b16 v[62:63], v17 offset:4096
    ds_read_b64_tr_b16 v[64:65], v17 offset:4608
    v_and_b32 v247, 0xffff0000, v111
    s_waitcnt lgkmcnt(4)
    v_mfma_f32_32x32x16_bf16 v[26:41], v[74:77], a[140:143], v[26:41]
    buffer_load_dwordx4 v125, s[28:31], s4 offen offset:2048 sc1 lds
    ds_read_b64_tr_b16 v[66:67], v19 offset:0
    v_lshlrev_b32 v114, 16, v128
    v_mfma_f32_32x32x16_bf16 v[26:41], v[78:81], a[172:175], v[26:41]
    ds_read_b64_tr_b16 v[68:69], v19 offset:512
    ds_read_b64_tr_b16 v[70:71], v19 offset:4096
    ds_read_b64_tr_b16 v[72:73], v19 offset:4608
    v_mfma_f32_32x32x16_bf16 v[26:41], v[82:85], a[204:207], v[26:41]
    buffer_load_dwordx4 v125, s[28:31], s4 offen offset:3072 sc1 lds
    ds_read_b64_tr_b16 v[74:75], v20 offset:0
    v_and_b32 v115, 0xffff0000, v128
    v_mfma_f32_32x32x16_bf16 v[26:41], v[86:89], a[236:239], v[26:41]
    ds_read_b64_tr_b16 v[76:77], v20 offset:512
    ds_read_b64_tr_b16 v[78:79], v20 offset:4096
    ds_read_b64_tr_b16 v[80:81], v20 offset:4608
    v_lshlrev_b32 v116, 16, v129
    s_waitcnt lgkmcnt(4)
    v_mfma_f32_32x32x16_bf16 v[26:41], v[58:61], a[16:19], v[26:41]
    s_add_u32 m0, s54, 32768
    s_mov_b32 s4, 1085440
    buffer_load_dwordx4 v125, s[28:31], s4 offen offset:0 sc1 lds
    ds_read_b64_tr_b16 v[82:83], v21 offset:0
    v_mfma_f32_32x32x16_bf16 v[26:41], v[62:65], a[48:51], v[26:41]
    ds_read_b64_tr_b16 v[84:85], v21 offset:512
    ds_read_b64_tr_b16 v[86:87], v21 offset:4096
    ds_read_b64_tr_b16 v[88:89], v21 offset:4608
    v_and_b32 v117, 0xffff0000, v129
    v_mfma_f32_32x32x16_bf16 v[26:41], v[66:69], a[80:83], v[26:41]
    buffer_load_dwordx4 v125, s[28:31], s4 offen offset:1024 sc1 lds
    s_waitcnt vmcnt(22)
    s_barrier
    ds_read_b64_tr_b16 v[58:59], v17 offset:16384
    v_mfma_f32_32x32x16_bf16 v[26:41], v[70:73], a[112:115], v[26:41]
    ds_read_b64_tr_b16 v[60:61], v17 offset:16896
    ds_read_b64_tr_b16 v[62:63], v17 offset:20480
    ds_read_b64_tr_b16 v[64:65], v17 offset:20992
    v_lshlrev_b32 v118, 16, v130
    s_waitcnt lgkmcnt(4)
    v_mfma_f32_32x32x16_bf16 v[26:41], v[74:77], a[144:147], v[26:41]
    buffer_load_dwordx4 v125, s[28:31], s4 offen offset:2048 sc1 lds
    ds_read_b64_tr_b16 v[66:67], v19 offset:16384
    v_and_b32 v119, 0xffff0000, v130
    v_mfma_f32_32x32x16_bf16 v[26:41], v[78:81], a[176:179], v[26:41]
    ds_read_b64_tr_b16 v[68:69], v19 offset:16896
    ds_read_b64_tr_b16 v[70:71], v19 offset:20480
    ds_read_b64_tr_b16 v[72:73], v19 offset:20992
    v_mfma_f32_32x32x16_bf16 v[26:41], v[82:85], a[208:211], v[26:41]
    buffer_load_dwordx4 v125, s[28:31], s4 offen offset:3072 sc1 lds
    ds_read_b64_tr_b16 v[74:75], v20 offset:16384
    v_lshlrev_b32 v120, 16, v131
    v_mfma_f32_32x32x16_bf16 v[26:41], v[86:89], a[240:243], v[26:41]
    ds_read_b64_tr_b16 v[76:77], v20 offset:16896
    ds_read_b64_tr_b16 v[78:79], v20 offset:20480
    ds_read_b64_tr_b16 v[80:81], v20 offset:20992
    v_and_b32 v121, 0xffff0000, v131
    s_waitcnt lgkmcnt(4)
    v_mfma_f32_32x32x16_bf16 v[26:41], v[58:61], a[20:23], v[26:41]
    s_add_u32 m0, s54, 49152
    s_mov_b32 s4, 1089536
    buffer_load_dwordx4 v125, s[28:31], s4 offen offset:0 sc1 lds
    ds_read_b64_tr_b16 v[82:83], v21 offset:16384
    v_mfma_f32_32x32x16_bf16 v[26:41], v[62:65], a[52:55], v[26:41]
    ds_read_b64_tr_b16 v[84:85], v21 offset:16896
    ds_read_b64_tr_b16 v[86:87], v21 offset:20480
    ds_read_b64_tr_b16 v[88:89], v21 offset:20992
    v_lshlrev_b32 v124, 16, v124
    v_mfma_f32_32x32x16_bf16 v[26:41], v[66:69], a[84:87], v[26:41]
    buffer_load_dwordx4 v125, s[28:31], s4 offen offset:1024 sc1 lds
    s_waitcnt vmcnt(22)
    s_barrier
    ds_read_b64_tr_b16 v[58:59], v17 offset:32768
    v_mfma_f32_32x32x16_bf16 v[26:41], v[70:73], a[116:119], v[26:41]
    ds_read_b64_tr_b16 v[60:61], v17 offset:33280
    ds_read_b64_tr_b16 v[62:63], v17 offset:36864
    ds_read_b64_tr_b16 v[64:65], v17 offset:37376
    v_mul_f32 v140, v124, v114
    s_waitcnt lgkmcnt(4)
    v_mfma_f32_32x32x16_bf16 v[26:41], v[74:77], a[148:151], v[26:41]
    buffer_load_dwordx4 v125, s[28:31], s4 offen offset:2048 sc1 lds
    ds_read_b64_tr_b16 v[66:67], v19 offset:32768
    v_mul_f32 v141, v124, v115
    v_mfma_f32_32x32x16_bf16 v[26:41], v[78:81], a[180:183], v[26:41]
    ds_read_b64_tr_b16 v[68:69], v19 offset:33280
    ds_read_b64_tr_b16 v[70:71], v19 offset:36864
    ds_read_b64_tr_b16 v[72:73], v19 offset:37376
    v_mfma_f32_32x32x16_bf16 v[26:41], v[82:85], a[212:215], v[26:41]
    buffer_load_dwordx4 v125, s[28:31], s4 offen offset:3072 sc1 lds
    ds_read_b64_tr_b16 v[74:75], v20 offset:32768
    v_mul_f32 v142, v124, v116
    v_mfma_f32_32x32x16_bf16 v[26:41], v[86:89], a[244:247], v[26:41]
    ds_read_b64_tr_b16 v[76:77], v20 offset:33280
    ds_read_b64_tr_b16 v[78:79], v20 offset:36864
    ds_read_b64_tr_b16 v[80:81], v20 offset:37376
    v_mul_f32 v143, v124, v117
    s_waitcnt lgkmcnt(4)
    v_mfma_f32_32x32x16_bf16 v[26:41], v[58:61], a[24:27], v[26:41]
    s_add_u32 m0, s54, 65536
    s_mov_b32 s4, 1093632
    buffer_load_dwordx4 v125, s[28:31], s4 offen offset:0 sc1 lds
    ds_read_b64_tr_b16 v[82:83], v21 offset:32768
    v_mfma_f32_32x32x16_bf16 v[26:41], v[62:65], a[56:59], v[26:41]
    ds_read_b64_tr_b16 v[84:85], v21 offset:33280
    ds_read_b64_tr_b16 v[86:87], v21 offset:36864
    ds_read_b64_tr_b16 v[88:89], v21 offset:37376
    v_mul_f32 v144, v124, v118
    v_mfma_f32_32x32x16_bf16 v[26:41], v[66:69], a[88:91], v[26:41]
    buffer_load_dwordx4 v125, s[28:31], s4 offen offset:1024 sc1 lds
    s_waitcnt vmcnt(14)
    s_barrier
    ds_read_b64_tr_b16 v[58:59], v5 offset:0
    v_mfma_f32_32x32x16_bf16 v[26:41], v[70:73], a[120:123], v[26:41]
    ds_read_b64_tr_b16 v[60:61], v5 offset:512
    ds_read_b64_tr_b16 v[62:63], v5 offset:4096
    ds_read_b64_tr_b16 v[64:65], v5 offset:4608
    v_mul_f32 v145, v124, v119
    s_waitcnt lgkmcnt(4)
    v_mfma_f32_32x32x16_bf16 v[26:41], v[74:77], a[152:155], v[26:41]
    buffer_load_dwordx4 v125, s[28:31], s4 offen offset:2048 sc1 lds
    ds_read_b64_tr_b16 v[66:67], v14 offset:0
    v_mul_f32 v146, v124, v120
    v_mfma_f32_32x32x16_bf16 v[26:41], v[78:81], a[184:187], v[26:41]
    ds_read_b64_tr_b16 v[68:69], v14 offset:512
    ds_read_b64_tr_b16 v[70:71], v14 offset:4096
    ds_read_b64_tr_b16 v[72:73], v14 offset:4608
    v_mfma_f32_32x32x16_bf16 v[26:41], v[82:85], a[216:219], v[26:41]
    buffer_load_dwordx4 v125, s[28:31], s4 offen offset:3072 sc1 lds
    ds_read_b64_tr_b16 v[74:75], v15 offset:0
    v_mul_f32 v147, v124, v121
    v_mfma_f32_32x32x16_bf16 v[26:41], v[86:89], a[248:251], v[26:41]
    ds_read_b64_tr_b16 v[76:77], v15 offset:512
    ds_read_b64_tr_b16 v[78:79], v15 offset:4096
    ds_read_b64_tr_b16 v[80:81], v15 offset:4608
    s_waitcnt lgkmcnt(4)
    v_mfma_f32_32x32x16_bf16 v[26:41], v[58:61], a[28:31], v[26:41]
    s_add_u32 m0, s54, 81920
    s_mov_b32 s4, 1097728
    buffer_load_dwordx4 v125, s[28:31], s4 offen offset:0 sc1 lds
    ds_read_b64_tr_b16 v[82:83], v16 offset:0
    v_mfma_f32_32x32x16_bf16 v[26:41], v[62:65], a[60:63], v[26:41]
    ds_read_b64_tr_b16 v[84:85], v16 offset:512
    ds_read_b64_tr_b16 v[86:87], v16 offset:4096
    ds_read_b64_tr_b16 v[88:89], v16 offset:4608
    v_mfma_f32_32x32x16_bf16 v[26:41], v[66:69], a[92:95], v[26:41]
    buffer_load_dwordx4 v125, s[28:31], s4 offen offset:1024 sc1 lds
    s_waitcnt vmcnt(14)
    s_barrier
    ds_read_b64_tr_b16 v[58:59], v5 offset:16384
    v_mfma_f32_32x32x16_bf16 v[26:41], v[70:73], a[124:127], v[26:41]
    ds_read_b64_tr_b16 v[60:61], v5 offset:16896
    ds_read_b64_tr_b16 v[62:63], v5 offset:20480
    ds_read_b64_tr_b16 v[64:65], v5 offset:20992
    s_waitcnt lgkmcnt(4)
    v_mfma_f32_32x32x16_bf16 v[26:41], v[74:77], a[156:159], v[26:41]
    buffer_load_dwordx4 v125, s[28:31], s4 offen offset:2048 sc1 lds
    ds_read_b64_tr_b16 v[66:67], v14 offset:16384
    v_mfma_f32_32x32x16_bf16 v[26:41], v[78:81], a[188:191], v[26:41]
    ds_read_b64_tr_b16 v[68:69], v14 offset:16896
    ds_read_b64_tr_b16 v[70:71], v14 offset:20480
    ds_read_b64_tr_b16 v[72:73], v14 offset:20992
    v_mfma_f32_32x32x16_bf16 v[26:41], v[82:85], a[220:223], v[26:41]
    buffer_load_dwordx4 v125, s[28:31], s4 offen offset:3072 sc1 lds
    ds_read_b64_tr_b16 v[74:75], v15 offset:16384
    v_mfma_f32_32x32x16_bf16 v[26:41], v[86:89], a[252:255], v[26:41]
    ds_read_b64_tr_b16 v[76:77], v15 offset:16896
    ds_read_b64_tr_b16 v[78:79], v15 offset:20480
    ds_read_b64_tr_b16 v[80:81], v15 offset:20992
    s_waitcnt lgkmcnt(4)
    v_mfma_f32_32x32x16_bf16 v[42:57], v[58:61], a[0:3], 0
    s_add_u32 m0, s54, 98304
    s_mov_b32 s4, 1101824
    buffer_load_dwordx4 v125, s[28:31], s4 offen offset:0 sc1 lds
    ds_read_b64_tr_b16 v[82:83], v16 offset:16384
    v_mfma_f32_32x32x16_bf16 v[42:57], v[62:65], a[32:35], v[42:57]
    ds_read_b64_tr_b16 v[84:85], v16 offset:16896
    ds_read_b64_tr_b16 v[86:87], v16 offset:20480
    ds_read_b64_tr_b16 v[88:89], v16 offset:20992
    ds_write_b128 v22, v[34:37] offset:0
    v_mfma_f32_32x32x16_bf16 v[42:57], v[66:69], a[64:67], v[42:57]
    buffer_load_dwordx4 v125, s[28:31], s4 offen offset:1024 sc1 lds
    s_waitcnt vmcnt(14)
    s_barrier
    ds_read_b64_tr_b16 v[58:59], v5 offset:32768
    ds_write_b128 v22, v[38:41] offset:1024
    v_mfma_f32_32x32x16_bf16 v[42:57], v[70:73], a[96:99], v[42:57]
    ds_read_b64_tr_b16 v[60:61], v5 offset:33280
    ds_read_b64_tr_b16 v[62:63], v5 offset:36864
    ds_read_b64_tr_b16 v[64:65], v5 offset:37376
    v_fma_f32 v26, v26, v114, v140
    v_fma_f32 v27, v27, v115, v141
    s_waitcnt lgkmcnt(6)
    v_mfma_f32_32x32x16_bf16 v[42:57], v[74:77], a[128:131], v[42:57]
    buffer_load_dwordx4 v125, s[28:31], s4 offen offset:2048 sc1 lds
    ds_read_b64_tr_b16 v[66:67], v14 offset:32768
    v_fma_f32 v28, v28, v116, v142
    v_fma_f32 v29, v29, v117, v143
    v_mfma_f32_32x32x16_bf16 v[42:57], v[78:81], a[160:163], v[42:57]
    s_cmp_eq_u32 s2, 0
    s_cselect_b32 s47, 0, 2146435072
    buffer_store_dword v18, v113, s[28:31], s47 offen sc1
    ds_read_b64_tr_b16 v[68:69], v14 offset:33280
    ds_read_b64_tr_b16 v[70:71], v14 offset:36864
    ds_read_b64_tr_b16 v[72:73], v14 offset:37376
    v_fma_f32 v30, v30, v118, v144
    v_fma_f32 v31, v31, v119, v145
    v_mfma_f32_32x32x16_bf16 v[42:57], v[82:85], a[192:195], v[42:57]
    buffer_load_dwordx4 v125, s[28:31], s4 offen offset:3072 sc1 lds
    ds_read_b64_tr_b16 v[74:75], v15 offset:32768
    v_fma_f32 v32, v32, v120, v146
    v_fma_f32 v33, v33, v121, v147
    v_mfma_f32_32x32x16_bf16 v[42:57], v[86:89], a[224:227], v[42:57]
    ds_read_b64_tr_b16 v[76:77], v15 offset:33280
    ds_read_b64_tr_b16 v[78:79], v15 offset:36864
    ds_read_b64_tr_b16 v[80:81], v15 offset:37376
    s_waitcnt lgkmcnt(4)
    v_mfma_f32_32x32x16_bf16 v[42:57], v[58:61], a[4:7], v[42:57]
    s_add_u32 m0, s54, 0
    s_mov_b32 s4, 1105920
    buffer_load_dwordx4 v125, s[28:31], s4 offen offset:0 sc1 lds
    ds_read_b64_tr_b16 v[82:83], v16 offset:32768
    v_mfma_f32_32x32x16_bf16 v[42:57], v[62:65], a[36:39], v[42:57]
    ds_read_b64_tr_b16 v[84:85], v16 offset:33280
    ds_read_b64_tr_b16 v[86:87], v16 offset:36864
    ds_read_b64_tr_b16 v[88:89], v16 offset:37376
    v_mfma_f32_32x32x16_bf16 v[42:57], v[66:69], a[68:71], v[42:57]
    buffer_load_dwordx4 v125, s[28:31], s4 offen offset:1024 sc1 lds
    s_waitcnt vmcnt(15)
    s_barrier
    ds_read_b64_tr_b16 v[58:59], v5 offset:49152
    ds_read_b128 v[90:93], v23 offset:0
    v_mfma_f32_32x32x16_bf16 v[42:57], v[70:73], a[100:103], v[42:57]
    ds_read_b64_tr_b16 v[60:61], v5 offset:49664
    ds_read_b64_tr_b16 v[62:63], v5 offset:53248
    ds_read_b64_tr_b16 v[64:65], v5 offset:53760
    ds_read_b128 v[94:97], v23 offset:1024
    s_waitcnt lgkmcnt(6)
    v_mfma_f32_32x32x16_bf16 v[42:57], v[74:77], a[132:135], v[42:57]
    buffer_load_dwordx4 v125, s[28:31], s4 offen offset:2048 sc1 lds
    ds_read_b64_tr_b16 v[66:67], v14 offset:49152
    v_mfma_f32_32x32x16_bf16 v[42:57], v[78:81], a[164:167], v[42:57]
    ds_read_b64_tr_b16 v[68:69], v14 offset:49664
    ds_read_b64_tr_b16 v[70:71], v14 offset:53248
    ds_read_b64_tr_b16 v[72:73], v14 offset:53760
    s_waitcnt lgkmcnt(8)
    v_fmac_f32 v26, v90, v114
    v_fmac_f32 v27, v91, v115
    v_mfma_f32_32x32x16_bf16 v[42:57], v[82:85], a[196:199], v[42:57]
    buffer_load_dwordx4 v125, s[28:31], s4 offen offset:3072 sc1 lds
    ds_read_b64_tr_b16 v[74:75], v15 offset:49152
    v_fmac_f32 v28, v92, v116
    v_fmac_f32 v29, v93, v117
    v_mfma_f32_32x32x16_bf16 v[42:57], v[86:89], a[228:231], v[42:57]
    ds_read_b64_tr_b16 v[76:77], v15 offset:49664
    ds_read_b64_tr_b16 v[78:79], v15 offset:53248
    ds_read_b64_tr_b16 v[80:81], v15 offset:53760
    s_waitcnt lgkmcnt(8)
    v_fmac_f32 v30, v94, v118
    v_fmac_f32 v31, v95, v119
    s_waitcnt lgkmcnt(4)
    v_mfma_f32_32x32x16_bf16 v[42:57], v[58:61], a[8:11], v[42:57]
    s_add_u32 m0, s54, 16384
    s_mov_b32 s4, 1110016
    buffer_load_dwordx4 v125, s[28:31], s4 offen offset:0 sc1 lds
    ds_read_b64_tr_b16 v[82:83], v16 offset:49152
    v_fmac_f32 v32, v96, v120
    v_fmac_f32 v33, v97, v121
    v_mfma_f32_32x32x16_bf16 v[42:57], v[62:65], a[40:43], v[42:57]
    ds_read_b64_tr_b16 v[84:85], v16 offset:49664
    ds_read_b64_tr_b16 v[86:87], v16 offset:53248
    ds_read_b64_tr_b16 v[88:89], v16 offset:53760
    v_cvt_pk_bf16_f32 v98, v26, v27
    v_cvt_pk_bf16_f32 v99, v28, v29
    v_mfma_f32_32x32x16_bf16 v[42:57], v[66:69], a[72:75], v[42:57]
    buffer_load_dwordx4 v125, s[28:31], s4 offen offset:1024 sc1 lds
    s_waitcnt vmcnt(15)
    s_barrier
    ds_read_b64_tr_b16 v[58:59], v17 offset:0
    v_cvt_pk_bf16_f32 v100, v30, v31
    v_cvt_pk_bf16_f32 v101, v32, v33
    v_mfma_f32_32x32x16_bf16 v[42:57], v[70:73], a[104:107], v[42:57]
    s_mov_b32 s47, 7340032
    buffer_store_dwordx4 v[98:101], v24, s[28:31], s47 offen sc1
    ds_read_b64_tr_b16 v[60:61], v17 offset:512
    ds_read_b64_tr_b16 v[62:63], v17 offset:4096
    ds_read_b64_tr_b16 v[64:65], v17 offset:4608
    s_waitcnt lgkmcnt(4)
    v_mfma_f32_32x32x16_bf16 v[42:57], v[74:77], a[136:139], v[42:57]
    buffer_load_dwordx4 v125, s[28:31], s4 offen offset:2048 sc1 lds
    ds_read_b64_tr_b16 v[66:67], v19 offset:0
    v_mfma_f32_32x32x16_bf16 v[42:57], v[78:81], a[168:171], v[42:57]
    ds_read_b64_tr_b16 v[68:69], v19 offset:512
    ds_read_b64_tr_b16 v[70:71], v19 offset:4096
    ds_read_b64_tr_b16 v[72:73], v19 offset:4608
    v_lshlrev_b32 v114, 16, v132
    v_mfma_f32_32x32x16_bf16 v[42:57], v[82:85], a[200:203], v[42:57]
    buffer_load_dwordx4 v125, s[28:31], s4 offen offset:3072 sc1 lds
    ds_read_b64_tr_b16 v[74:75], v20 offset:0
    v_mfma_f32_32x32x16_bf16 v[42:57], v[86:89], a[232:235], v[42:57]
    ds_read_b64_tr_b16 v[76:77], v20 offset:512
    ds_read_b64_tr_b16 v[78:79], v20 offset:4096
    ds_read_b64_tr_b16 v[80:81], v20 offset:4608
    v_and_b32 v115, 0xffff0000, v132
    s_waitcnt lgkmcnt(4)
    v_mfma_f32_32x32x16_bf16 v[42:57], v[58:61], a[12:15], v[42:57]
    s_add_u32 m0, s54, 32768
    s_mov_b32 s4, 1114112
    buffer_load_dwordx4 v125, s[28:31], s4 offen offset:0 sc1 lds
    ds_read_b64_tr_b16 v[82:83], v21 offset:0
    v_mfma_f32_32x32x16_bf16 v[42:57], v[62:65], a[44:47], v[42:57]
    ds_read_b64_tr_b16 v[84:85], v21 offset:512
    ds_read_b64_tr_b16 v[86:87], v21 offset:4096
    ds_read_b64_tr_b16 v[88:89], v21 offset:4608
    v_lshlrev_b32 v116, 16, v133
    v_mfma_f32_32x32x16_bf16 v[42:57], v[66:69], a[76:79], v[42:57]
    buffer_load_dwordx4 v125, s[28:31], s4 offen offset:1024 sc1 lds
    s_waitcnt vmcnt(16)
    s_barrier
    ds_read_b64_tr_b16 v[58:59], v17 offset:16384
    v_mfma_f32_32x32x16_bf16 v[42:57], v[70:73], a[108:111], v[42:57]
    ds_read_b64_tr_b16 v[60:61], v17 offset:16896
    ds_read_b64_tr_b16 v[62:63], v17 offset:20480
    ds_read_b64_tr_b16 v[64:65], v17 offset:20992
    v_and_b32 v117, 0xffff0000, v133
    s_waitcnt lgkmcnt(4)
    v_mfma_f32_32x32x16_bf16 v[42:57], v[74:77], a[140:143], v[42:57]
    s_sub_u32 s4, s4, s58
    buffer_load_dwordx4 v125, s[28:31], s4 offen offset:2048 sc1 lds
    ds_read_b64_tr_b16 v[66:67], v19 offset:16384
    v_mfma_f32_32x32x16_bf16 v[42:57], v[78:81], a[172:175], v[42:57]
    ds_read_b64_tr_b16 v[68:69], v19 offset:16896
    ds_read_b64_tr_b16 v[70:71], v19 offset:20480
    ds_read_b64_tr_b16 v[72:73], v19 offset:20992
    v_lshlrev_b32 v118, 16, v134
    v_mfma_f32_32x32x16_bf16 v[42:57], v[82:85], a[204:207], v[42:57]
    s_add_u32 m0, s54, 49152
    s_mov_b32 s4, 1118208
    buffer_load_dwordx4 v125, s[28:31], s4 offen offset:0 sc1 lds
    ds_read_b64_tr_b16 v[74:75], v20 offset:16384
    v_mfma_f32_32x32x16_bf16 v[42:57], v[86:89], a[236:239], v[42:57]
    ds_read_b64_tr_b16 v[76:77], v20 offset:16896
    ds_read_b64_tr_b16 v[78:79], v20 offset:20480
    ds_read_b64_tr_b16 v[80:81], v20 offset:20992
    v_and_b32 v119, 0xffff0000, v134
    s_waitcnt lgkmcnt(4)
    v_mfma_f32_32x32x16_bf16 v[42:57], v[58:61], a[16:19], v[42:57]
    buffer_load_dwordx4 v125, s[28:31], s4 offen offset:1024 sc1 lds
    ds_read_b64_tr_b16 v[82:83], v21 offset:16384
    v_mfma_f32_32x32x16_bf16 v[42:57], v[62:65], a[48:51], v[42:57]
    ds_read_b64_tr_b16 v[84:85], v21 offset:16896
    ds_read_b64_tr_b16 v[86:87], v21 offset:20480
    ds_read_b64_tr_b16 v[88:89], v21 offset:20992
    v_lshlrev_b32 v120, 16, v135
    v_mfma_f32_32x32x16_bf16 v[42:57], v[66:69], a[80:83], v[42:57]
    s_sub_u32 s4, s4, s58
    buffer_load_dwordx4 v125, s[28:31], s4 offen offset:2048 sc1 lds
    s_waitcnt vmcnt(15)
    s_barrier
    ds_read_b64_tr_b16 v[58:59], v17 offset:32768
    v_mfma_f32_32x32x16_bf16 v[42:57], v[70:73], a[112:115], v[42:57]
    ds_read_b64_tr_b16 v[60:61], v17 offset:33280
    ds_read_b64_tr_b16 v[62:63], v17 offset:36864
    ds_read_b64_tr_b16 v[64:65], v17 offset:37376
    v_and_b32 v121, 0xffff0000, v135
    s_waitcnt lgkmcnt(4)
    v_mfma_f32_32x32x16_bf16 v[42:57], v[74:77], a[144:147], v[42:57]
    s_add_u32 m0, s54, 65536
    s_mov_b32 s4, 1122304
    buffer_load_dwordx4 v125, s[28:31], s4 offen offset:0 sc1 lds
    ds_read_b64_tr_b16 v[66:67], v19 offset:32768
    v_mfma_f32_32x32x16_bf16 v[42:57], v[78:81], a[176:179], v[42:57]
    ds_read_b64_tr_b16 v[68:69], v19 offset:33280
    ds_read_b64_tr_b16 v[70:71], v19 offset:36864
    ds_read_b64_tr_b16 v[72:73], v19 offset:37376
    v_mul_f32 v140, v124, v114
    v_mfma_f32_32x32x16_bf16 v[42:57], v[82:85], a[208:211], v[42:57]
    buffer_load_dwordx4 v125, s[28:31], s4 offen offset:1024 sc1 lds
    ds_read_b64_tr_b16 v[74:75], v20 offset:32768
    v_mfma_f32_32x32x16_bf16 v[42:57], v[86:89], a[240:243], v[42:57]
    ds_read_b64_tr_b16 v[76:77], v20 offset:33280
    ds_read_b64_tr_b16 v[78:79], v20 offset:36864
    ds_read_b64_tr_b16 v[80:81], v20 offset:37376
    v_mul_f32 v141, v124, v115
    s_waitcnt lgkmcnt(4)
    v_mfma_f32_32x32x16_bf16 v[42:57], v[58:61], a[20:23], v[42:57]
    s_sub_u32 s4, s4, s58
    buffer_load_dwordx4 v125, s[28:31], s4 offen offset:2048 sc1 lds
    ds_read_b64_tr_b16 v[82:83], v21 offset:32768
    v_mfma_f32_32x32x16_bf16 v[42:57], v[62:65], a[52:55], v[42:57]
    ds_read_b64_tr_b16 v[84:85], v21 offset:33280
    ds_read_b64_tr_b16 v[86:87], v21 offset:36864
    ds_read_b64_tr_b16 v[88:89], v21 offset:37376
    v_mul_f32 v142, v124, v116
    v_mfma_f32_32x32x16_bf16 v[42:57], v[66:69], a[84:87], v[42:57]
    s_waitcnt vmcnt(14)
    s_barrier
    ds_read_b64_tr_b16 v[58:59], v5 offset:0
    v_mfma_f32_32x32x16_bf16 v[42:57], v[70:73], a[116:119], v[42:57]
    ds_read_b64_tr_b16 v[60:61], v5 offset:512
    ds_read_b64_tr_b16 v[62:63], v5 offset:4096
    ds_read_b64_tr_b16 v[64:65], v5 offset:4608
    v_mul_f32 v143, v124, v117
    s_waitcnt lgkmcnt(4)
    v_mfma_f32_32x32x16_bf16 v[42:57], v[74:77], a[148:151], v[42:57]
    s_add_u32 m0, s54, 81920
    s_mov_b32 s4, 1126400
    buffer_load_dwordx4 v125, s[28:31], s4 offen offset:0 sc1 lds
    ds_read_b64_tr_b16 v[66:67], v14 offset:0
    v_mfma_f32_32x32x16_bf16 v[42:57], v[78:81], a[180:183], v[42:57]
    ds_read_b64_tr_b16 v[68:69], v14 offset:512
    ds_read_b64_tr_b16 v[70:71], v14 offset:4096
    ds_read_b64_tr_b16 v[72:73], v14 offset:4608
    v_mul_f32 v144, v124, v118
    v_mfma_f32_32x32x16_bf16 v[42:57], v[82:85], a[212:215], v[42:57]
    buffer_load_dwordx4 v125, s[28:31], s4 offen offset:1024 sc1 lds
    ds_read_b64_tr_b16 v[74:75], v15 offset:0
    v_mfma_f32_32x32x16_bf16 v[42:57], v[86:89], a[244:247], v[42:57]
    ds_read_b64_tr_b16 v[76:77], v15 offset:512
    ds_read_b64_tr_b16 v[78:79], v15 offset:4096
    ds_read_b64_tr_b16 v[80:81], v15 offset:4608
    v_mul_f32 v145, v124, v119
    s_waitcnt lgkmcnt(4)
    v_mfma_f32_32x32x16_bf16 v[42:57], v[58:61], a[24:27], v[42:57]
    s_sub_u32 s4, s4, s58
    buffer_load_dwordx4 v125, s[28:31], s4 offen offset:2048 sc1 lds
    ds_read_b64_tr_b16 v[82:83], v16 offset:0
    v_mfma_f32_32x32x16_bf16 v[42:57], v[62:65], a[56:59], v[42:57]
    ds_read_b64_tr_b16 v[84:85], v16 offset:512
    ds_read_b64_tr_b16 v[86:87], v16 offset:4096
    ds_read_b64_tr_b16 v[88:89], v16 offset:4608
    v_mul_f32 v146, v124, v120
    v_mfma_f32_32x32x16_bf16 v[42:57], v[66:69], a[88:91], v[42:57]
    s_mov_b32 s5, 7340032
    buffer_load_dwordx4 v[168:171], v254, s[28:31], s5 offen offset:0 sc1
    s_waitcnt vmcnt(13)
    s_barrier
    ds_read_b64_tr_b16 v[58:59], v5 offset:16384
    v_mfma_f32_32x32x16_bf16 v[42:57], v[70:73], a[120:123], v[42:57]
    ds_read_b64_tr_b16 v[60:61], v5 offset:16896
    ds_read_b64_tr_b16 v[62:63], v5 offset:20480
    ds_read_b64_tr_b16 v[64:65], v5 offset:20992
    v_mul_f32 v147, v124, v121
    s_waitcnt lgkmcnt(4)
    v_mfma_f32_32x32x16_bf16 v[42:57], v[74:77], a[152:155], v[42:57]
    s_add_u32 m0, s54, 98304
    s_mov_b32 s4, 1130496
    buffer_load_dwordx4 v125, s[28:31], s4 offen offset:0 sc1 lds
    ds_read_b64_tr_b16 v[66:67], v14 offset:16384
    v_mfma_f32_32x32x16_bf16 v[42:57], v[78:81], a[184:187], v[42:57]
    ds_read_b64_tr_b16 v[68:69], v14 offset:16896
    ds_read_b64_tr_b16 v[70:71], v14 offset:20480
    ds_read_b64_tr_b16 v[72:73], v14 offset:20992
    v_mfma_f32_32x32x16_bf16 v[42:57], v[82:85], a[216:219], v[42:57]
    buffer_load_dwordx4 v125, s[28:31], s4 offen offset:1024 sc1 lds
    ds_read_b64_tr_b16 v[74:75], v15 offset:16384
    v_mfma_f32_32x32x16_bf16 v[42:57], v[86:89], a[248:251], v[42:57]
    ds_read_b64_tr_b16 v[76:77], v15 offset:16896
    ds_read_b64_tr_b16 v[78:79], v15 offset:20480
    ds_read_b64_tr_b16 v[80:81], v15 offset:20992
    s_waitcnt lgkmcnt(4)
    v_mfma_f32_32x32x16_bf16 v[42:57], v[58:61], a[28:31], v[42:57]
    s_sub_u32 s4, s4, s58
    buffer_load_dwordx4 v125, s[28:31], s4 offen offset:2048 sc1 lds
    ds_read_b64_tr_b16 v[82:83], v16 offset:16384
    v_mfma_f32_32x32x16_bf16 v[42:57], v[62:65], a[60:63], v[42:57]
    ds_read_b64_tr_b16 v[84:85], v16 offset:16896
    ds_read_b64_tr_b16 v[86:87], v16 offset:20480
    ds_read_b64_tr_b16 v[88:89], v16 offset:20992
    v_mfma_f32_32x32x16_bf16 v[42:57], v[66:69], a[92:95], v[42:57]
    buffer_load_dwordx4 v[172:175], v254, s[28:31], s5 offen offset:1024 sc1
    s_waitcnt vmcnt(14)
    s_barrier
    ds_read_b64_tr_b16 v[58:59], v5 offset:32768
    v_mfma_f32_32x32x16_bf16 v[42:57], v[70:73], a[124:127], v[42:57]
    ds_read_b64_tr_b16 v[60:61], v5 offset:33280
    ds_read_b64_tr_b16 v[62:63], v5 offset:36864
    ds_read_b64_tr_b16 v[64:65], v5 offset:37376
    s_waitcnt lgkmcnt(4)
    v_mfma_f32_32x32x16_bf16 v[42:57], v[74:77], a[156:159], v[42:57]
    s_add_u32 m0, s54, 0
    s_mov_b32 s4, 1134592
    buffer_load_dwordx4 v125, s[28:31], s4 offen offset:0 sc1 lds
    ds_read_b64_tr_b16 v[66:67], v14 offset:32768
    v_mfma_f32_32x32x16_bf16 v[42:57], v[78:81], a[188:191], v[42:57]
    ds_read_b64_tr_b16 v[68:69], v14 offset:33280
    ds_read_b64_tr_b16 v[70:71], v14 offset:36864
    ds_read_b64_tr_b16 v[72:73], v14 offset:37376
    v_mfma_f32_32x32x16_bf16 v[42:57], v[82:85], a[220:223], v[42:57]
    buffer_load_dwordx4 v125, s[28:31], s4 offen offset:1024 sc1 lds
    ds_read_b64_tr_b16 v[74:75], v15 offset:32768
    v_mfma_f32_32x32x16_bf16 v[42:57], v[86:89], a[252:255], v[42:57]
    ds_read_b64_tr_b16 v[76:77], v15 offset:33280
    ds_read_b64_tr_b16 v[78:79], v15 offset:36864
    ds_read_b64_tr_b16 v[80:81], v15 offset:37376
    s_waitcnt lgkmcnt(4)
    v_mfma_f32_32x32x16_bf16 v[26:41], v[58:61], a[0:3], 0
    s_sub_u32 s4, s4, s58
    buffer_load_dwordx4 v125, s[28:31], s4 offen offset:2048 sc1 lds
    ds_read_b64_tr_b16 v[82:83], v16 offset:32768
    v_mfma_f32_32x32x16_bf16 v[26:41], v[62:65], a[32:35], v[26:41]
    ds_read_b64_tr_b16 v[84:85], v16 offset:33280
    ds_read_b64_tr_b16 v[86:87], v16 offset:36864
    ds_read_b64_tr_b16 v[88:89], v16 offset:37376
    ds_write_b128 v22, v[50:53] offset:0
    v_mfma_f32_32x32x16_bf16 v[26:41], v[66:69], a[64:67], v[26:41]
    buffer_load_dwordx4 v[176:179], v254, s[28:31], s5 offen offset:2048 sc1
    s_waitcnt vmcnt(15)
    s_barrier
    ds_read_b64_tr_b16 v[58:59], v5 offset:49152
    ds_write_b128 v22, v[54:57] offset:1024
    v_mfma_f32_32x32x16_bf16 v[26:41], v[70:73], a[96:99], v[26:41]
    ds_read_b64_tr_b16 v[60:61], v5 offset:49664
    ds_read_b64_tr_b16 v[62:63], v5 offset:53248
    ds_read_b64_tr_b16 v[64:65], v5 offset:53760
    v_fma_f32 v42, v42, v114, v140
    v_fma_f32 v43, v43, v115, v141
    s_waitcnt lgkmcnt(6)
    v_mfma_f32_32x32x16_bf16 v[26:41], v[74:77], a[128:131], v[26:41]
    s_add_u32 m0, s54, 16384
    s_mov_b32 s4, 1138688
    buffer_load_dwordx4 v125, s[28:31], s4 offen offset:0 sc1 lds
    ds_read_b64_tr_b16 v[66:67], v14 offset:49152
    v_fma_f32 v44, v44, v116, v142
    v_fma_f32 v45, v45, v117, v143
    v_mfma_f32_32x32x16_bf16 v[26:41], v[78:81], a[160:163], v[26:41]
    ds_read_b64_tr_b16 v[68:69], v14 offset:49664
    ds_read_b64_tr_b16 v[70:71], v14 offset:53248
    ds_read_b64_tr_b16 v[72:73], v14 offset:53760
    v_fma_f32 v46, v46, v118, v144
    v_fma_f32 v47, v47, v119, v145
    v_mfma_f32_32x32x16_bf16 v[26:41], v[82:85], a[192:195], v[26:41]
    buffer_load_dwordx4 v125, s[28:31], s4 offen offset:1024 sc1 lds
    ds_read_b64_tr_b16 v[74:75], v15 offset:49152
    v_fma_f32 v48, v48, v120, v146
    v_fma_f32 v49, v49, v121, v147
    v_mfma_f32_32x32x16_bf16 v[26:41], v[86:89], a[224:227], v[26:41]
    ds_read_b64_tr_b16 v[76:77], v15 offset:49664
    ds_read_b64_tr_b16 v[78:79], v15 offset:53248
    ds_read_b64_tr_b16 v[80:81], v15 offset:53760
    s_waitcnt lgkmcnt(4)
    v_mfma_f32_32x32x16_bf16 v[26:41], v[58:61], a[4:7], v[26:41]
    s_sub_u32 s4, s4, s58
    buffer_load_dwordx4 v125, s[28:31], s4 offen offset:2048 sc1 lds
    ds_read_b64_tr_b16 v[82:83], v16 offset:49152
    v_mfma_f32_32x32x16_bf16 v[26:41], v[62:65], a[36:39], v[26:41]
    ds_read_b64_tr_b16 v[84:85], v16 offset:49664
    ds_read_b64_tr_b16 v[86:87], v16 offset:53248
    ds_read_b64_tr_b16 v[88:89], v16 offset:53760
    v_mfma_f32_32x32x16_bf16 v[26:41], v[66:69], a[68:71], v[26:41]
    buffer_load_dwordx4 v[180:183], v254, s[28:31], s5 offen offset:3072 sc1
    s_waitcnt vmcnt(16)
    s_barrier
    ds_read_b64_tr_b16 v[58:59], v17 offset:0
    ds_read_b128 v[90:93], v23 offset:0
    v_mfma_f32_32x32x16_bf16 v[26:41], v[70:73], a[100:103], v[26:41]
    ds_read_b64_tr_b16 v[60:61], v17 offset:512
    ds_read_b64_tr_b16 v[62:63], v17 offset:4096
    ds_read_b64_tr_b16 v[64:65], v17 offset:4608
    ds_read_b128 v[94:97], v23 offset:1024
    s_waitcnt lgkmcnt(6)
    v_mfma_f32_32x32x16_bf16 v[26:41], v[74:77], a[132:135], v[26:41]
    s_add_u32 m0, s54, 32768
    s_mov_b32 s4, 1142784
    buffer_load_dwordx4 v125, s[28:31], s4 offen offset:0 sc1 lds
    ds_read_b64_tr_b16 v[66:67], v19 offset:0
    v_mfma_f32_32x32x16_bf16 v[26:41], v[78:81], a[164:167], v[26:41]
    ds_read_b64_tr_b16 v[68:69], v19 offset:512
    ds_read_b64_tr_b16 v[70:71], v19 offset:4096
    ds_read_b64_tr_b16 v[72:73], v19 offset:4608
    s_waitcnt lgkmcnt(8)
    v_fmac_f32 v42, v90, v114
    v_fmac_f32 v43, v91, v115
    v_mfma_f32_32x32x16_bf16 v[26:41], v[82:85], a[196:199], v[26:41]
    buffer_load_dwordx4 v125, s[28:31], s4 offen offset:1024 sc1 lds
    ds_read_b64_tr_b16 v[74:75], v20 offset:0
    v_fmac_f32 v44, v92, v116
    v_fmac_f32 v45, v93, v117
    v_mfma_f32_32x32x16_bf16 v[26:41], v[86:89], a[228:231], v[26:41]
    ds_read_b64_tr_b16 v[76:77], v20 offset:512
    ds_read_b64_tr_b16 v[78:79], v20 offset:4096
    ds_read_b64_tr_b16 v[80:81], v20 offset:4608
    s_waitcnt lgkmcnt(8)
    v_fmac_f32 v46, v94, v118
    v_fmac_f32 v47, v95, v119
    s_waitcnt lgkmcnt(4)
    v_mfma_f32_32x32x16_bf16 v[26:41], v[58:61], a[8:11], v[26:41]
    s_sub_u32 s4, s4, s58
    buffer_load_dwordx4 v125, s[28:31], s4 offen offset:2048 sc1 lds
    ds_read_b64_tr_b16 v[82:83], v21 offset:0
    v_fmac_f32 v48, v96, v120
    v_fmac_f32 v49, v97, v121
    v_mfma_f32_32x32x16_bf16 v[26:41], v[62:65], a[40:43], v[26:41]
    ds_read_b64_tr_b16 v[84:85], v21 offset:512
    ds_read_b64_tr_b16 v[86:87], v21 offset:4096
    ds_read_b64_tr_b16 v[88:89], v21 offset:4608
    v_cvt_pk_bf16_f32 v98, v42, v43
    v_cvt_pk_bf16_f32 v99, v44, v45
    v_mfma_f32_32x32x16_bf16 v[26:41], v[66:69], a[72:75], v[26:41]
    s_mov_b32 s5, 7344128
    buffer_load_dwordx4 v[184:187], v254, s[28:31], s5 offen offset:0 sc1
    s_waitcnt vmcnt(17)
    s_barrier
    ds_read_b64_tr_b16 v[58:59], v17 offset:16384
    v_cvt_pk_bf16_f32 v100, v46, v47
    v_cvt_pk_bf16_f32 v101, v48, v49
    v_mfma_f32_32x32x16_bf16 v[26:41], v[70:73], a[104:107], v[26:41]
    s_mov_b32 s47, 7372800
    buffer_store_dwordx4 v[98:101], v24, s[28:31], s47 offen sc1
    ds_read_b64_tr_b16 v[60:61], v17 offset:16896
    ds_read_b64_tr_b16 v[62:63], v17 offset:20480
    ds_read_b64_tr_b16 v[64:65], v17 offset:20992
    s_waitcnt lgkmcnt(4)
    v_mfma_f32_32x32x16_bf16 v[26:41], v[74:77], a[136:139], v[26:41]
    buffer_load_dwordx4 v[188:191], v254, s[28:31], s5 offen offset:1024 sc1
    ds_read_b64_tr_b16 v[66:67], v19 offset:16384
    v_mfma_f32_32x32x16_bf16 v[26:41], v[78:81], a[168:171], v[26:41]
    ds_read_b64_tr_b16 v[68:69], v19 offset:16896
    ds_read_b64_tr_b16 v[70:71], v19 offset:20480
    ds_read_b64_tr_b16 v[72:73], v19 offset:20992
    v_lshlrev_b32 v114, 16, v136
    v_mfma_f32_32x32x16_bf16 v[26:41], v[82:85], a[200:203], v[26:41]
    buffer_load_dwordx4 v[192:195], v254, s[28:31], s5 offen offset:2048 sc1
    ds_read_b64_tr_b16 v[74:75], v20 offset:16384
    v_mfma_f32_32x32x16_bf16 v[26:41], v[86:89], a[232:235], v[26:41]
    ds_read_b64_tr_b16 v[76:77], v20 offset:16896
    ds_read_b64_tr_b16 v[78:79], v20 offset:20480
    ds_read_b64_tr_b16 v[80:81], v20 offset:20992
    v_and_b32 v115, 0xffff0000, v136
    s_waitcnt lgkmcnt(4)
    v_mfma_f32_32x32x16_bf16 v[26:41], v[58:61], a[12:15], v[26:41]
    buffer_load_dwordx4 v[196:199], v254, s[28:31], s5 offen offset:3072 sc1
    ds_read_b64_tr_b16 v[82:83], v21 offset:16384
    v_mfma_f32_32x32x16_bf16 v[26:41], v[62:65], a[44:47], v[26:41]
    ds_read_b64_tr_b16 v[84:85], v21 offset:16896
    ds_read_b64_tr_b16 v[86:87], v21 offset:20480
    ds_read_b64_tr_b16 v[88:89], v21 offset:20992
    v_lshlrev_b32 v116, 16, v137
    v_mfma_f32_32x32x16_bf16 v[26:41], v[66:69], a[76:79], v[26:41]
    s_add_u32 m0, s54, 49152
    s_mov_b32 s50, 32768
    buffer_load_dwordx4 v102, s[20:23], s50 offen  lds
    s_waitcnt vmcnt(18)
    s_barrier
    ds_read_b64_tr_b16 v[58:59], v17 offset:32768
    v_mfma_f32_32x32x16_bf16 v[26:41], v[70:73], a[108:111], v[26:41]
    ds_read_b64_tr_b16 v[60:61], v17 offset:33280
    ds_read_b64_tr_b16 v[62:63], v17 offset:36864
    ds_read_b64_tr_b16 v[64:65], v17 offset:37376
    v_and_b32 v117, 0xffff0000, v137
    s_waitcnt lgkmcnt(4)
    v_mfma_f32_32x32x16_bf16 v[26:41], v[74:77], a[140:143], v[26:41]
    s_add_u32 m0, s54, 50176
    s_mov_b32 s50, 122880
    buffer_load_dwordx4 v102, s[20:23], s50 offen  lds
    ds_read_b64_tr_b16 v[66:67], v19 offset:32768
    v_mfma_f32_32x32x16_bf16 v[26:41], v[78:81], a[172:175], v[26:41]
    ds_read_b64_tr_b16 v[68:69], v19 offset:33280
    ds_read_b64_tr_b16 v[70:71], v19 offset:36864
    ds_read_b64_tr_b16 v[72:73], v19 offset:37376
    v_lshlrev_b32 v118, 16, v138
    v_mfma_f32_32x32x16_bf16 v[26:41], v[82:85], a[204:207], v[26:41]
    s_add_u32 m0, s54, 51200
    s_mov_b32 s50, 212992
    buffer_load_dwordx4 v102, s[20:23], s50 offen  lds
    ds_read_b64_tr_b16 v[74:75], v20 offset:32768
    v_mfma_f32_32x32x16_bf16 v[26:41], v[86:89], a[236:239], v[26:41]
    ds_read_b64_tr_b16 v[76:77], v20 offset:33280
    ds_read_b64_tr_b16 v[78:79], v20 offset:36864
    ds_read_b64_tr_b16 v[80:81], v20 offset:37376
    v_and_b32 v119, 0xffff0000, v138
    s_waitcnt lgkmcnt(4)
    v_mfma_f32_32x32x16_bf16 v[26:41], v[58:61], a[16:19], v[26:41]
    s_add_u32 m0, s54, 52224
    s_mov_b32 s50, 303104
    buffer_load_dwordx4 v102, s[20:23], s50 offen  lds
    ds_read_b64_tr_b16 v[82:83], v21 offset:32768
    v_mfma_f32_32x32x16_bf16 v[26:41], v[62:65], a[48:51], v[26:41]
    ds_read_b64_tr_b16 v[84:85], v21 offset:33280
    ds_read_b64_tr_b16 v[86:87], v21 offset:36864
    ds_read_b64_tr_b16 v[88:89], v21 offset:37376
    v_lshlrev_b32 v120, 16, v139
    v_mfma_f32_32x32x16_bf16 v[26:41], v[66:69], a[80:83], v[26:41]
    s_waitcnt vmcnt(17)
    s_barrier
    ds_read_b64_tr_b16 v[58:59], v5 offset:0
    v_mfma_f32_32x32x16_bf16 v[26:41], v[70:73], a[112:115], v[26:41]
    ds_read_b64_tr_b16 v[60:61], v5 offset:512
    ds_read_b64_tr_b16 v[62:63], v5 offset:4096
    ds_read_b64_tr_b16 v[64:65], v5 offset:4608
    v_and_b32 v121, 0xffff0000, v139
    s_waitcnt lgkmcnt(4)
    v_mfma_f32_32x32x16_bf16 v[26:41], v[74:77], a[144:147], v[26:41]
    s_add_u32 m0, s54, 81920
    s_mov_b32 s50, 393216
    buffer_load_dwordx4 v102, s[20:23], s50 offen  lds
    ds_read_b64_tr_b16 v[66:67], v14 offset:0
    v_mfma_f32_32x32x16_bf16 v[26:41], v[78:81], a[176:179], v[26:41]
    ds_read_b64_tr_b16 v[68:69], v14 offset:512
    ds_read_b64_tr_b16 v[70:71], v14 offset:4096
    ds_read_b64_tr_b16 v[72:73], v14 offset:4608
    v_mul_f32 v140, v124, v114
    v_mfma_f32_32x32x16_bf16 v[26:41], v[82:85], a[208:211], v[26:41]
    s_add_u32 m0, s54, 82944
    s_mov_b32 s50, 483328
    buffer_load_dwordx4 v102, s[20:23], s50 offen  lds
    ds_read_b64_tr_b16 v[74:75], v15 offset:0
    v_mfma_f32_32x32x16_bf16 v[26:41], v[86:89], a[240:243], v[26:41]
    ds_read_b64_tr_b16 v[76:77], v15 offset:512
    ds_read_b64_tr_b16 v[78:79], v15 offset:4096
    ds_read_b64_tr_b16 v[80:81], v15 offset:4608
    v_mul_f32 v141, v124, v115
    s_waitcnt lgkmcnt(4)
    v_mfma_f32_32x32x16_bf16 v[26:41], v[58:61], a[20:23], v[26:41]
    s_add_u32 m0, s54, 83968
    s_mov_b32 s50, 573440
    buffer_load_dwordx4 v102, s[20:23], s50 offen  lds
    ds_read_b64_tr_b16 v[82:83], v16 offset:0
    v_mfma_f32_32x32x16_bf16 v[26:41], v[62:65], a[52:55], v[26:41]
    ds_read_b64_tr_b16 v[84:85], v16 offset:512
    ds_read_b64_tr_b16 v[86:87], v16 offset:4096
    ds_read_b64_tr_b16 v[88:89], v16 offset:4608
    v_mul_f32 v142, v124, v116
    v_mfma_f32_32x32x16_bf16 v[26:41], v[66:69], a[84:87], v[26:41]
    s_add_u32 m0, s54, 84992
    s_mov_b32 s50, 655360
    buffer_load_dwordx4 v102, s[20:23], s50 offen  lds
    s_waitcnt vmcnt(17)
    s_barrier
    ds_read_b64_tr_b16 v[58:59], v5 offset:16384
    v_mfma_f32_32x32x16_bf16 v[26:41], v[70:73], a[116:119], v[26:41]
    ds_read_b64_tr_b16 v[60:61], v5 offset:16896
    ds_read_b64_tr_b16 v[62:63], v5 offset:20480
    ds_read_b64_tr_b16 v[64:65], v5 offset:20992
    v_mul_f32 v143, v124, v117
    s_mov_b32 s52, 0
    s_waitcnt vmcnt(8)
L_rh0:
    v_max3_i32 v6, v168, v172, v176
    v_max3_i32 v6, v6, v180, v184
    v_max3_i32 v6, v6, v188, v192
    v_max_i32 v6, v6, v196
    v_cmp_eq_u32 vcc, 2139193217, v6
    s_cbranch_vccnz L_sh0
L_bh0:
    s_waitcnt lgkmcnt(4)
    v_mfma_f32_32x32x16_bf16 v[26:41], v[74:77], a[148:151], v[26:41]
    s_lshl_b32 s48, s53, 14
    s_add_u32 m0, s54, 65536
    s_add_u32 s48, s48, s54
    s_add_u32 s48, s48, s46
    buffer_load_dwordx4 v126, s[28:31], s48 offen sc1 lds
    ds_read_b64_tr_b16 v[66:67], v14 offset:16384
    v_mfma_f32_32x32x16_bf16 v[26:41], v[78:81], a[180:183], v[26:41]
    ds_read_b64_tr_b16 v[68:69], v14 offset:16896
    ds_read_b64_tr_b16 v[70:71], v14 offset:20480
    ds_read_b64_tr_b16 v[72:73], v14 offset:20992
    v_mul_f32 v144, v124, v118
    v_mfma_f32_32x32x16_bf16 v[26:41], v[82:85], a[212:215], v[26:41]
    buffer_load_dwordx4 v126, s[28:31], s48 offen offset:1024 sc1 lds
    ds_read_b64_tr_b16 v[74:75], v15 offset:16384
    v_mfma_f32_32x32x16_bf16 v[26:41], v[86:89], a[244:247], v[26:41]
    ds_read_b64_tr_b16 v[76:77], v15 offset:16896
    ds_read_b64_tr_b16 v[78:79], v15 offset:20480
    ds_read_b64_tr_b16 v[80:81], v15 offset:20992
    v_mul_f32 v145, v124, v119
    s_waitcnt lgkmcnt(4)
    v_mfma_f32_32x32x16_bf16 v[26:41], v[58:61], a[24:27], v[26:41]
    buffer_load_dwordx4 v126, s[28:31], s48 offen offset:2048 sc1 lds
    ds_read_b64_tr_b16 v[82:83], v16 offset:16384
    v_mfma_f32_32x32x16_bf16 v[26:41], v[62:65], a[56:59], v[26:41]
    ds_read_b64_tr_b16 v[84:85], v16 offset:16896
    ds_read_b64_tr_b16 v[86:87], v16 offset:20480
    ds_read_b64_tr_b16 v[88:89], v16 offset:20992
    v_mul_f32 v146, v124, v120
    v_mfma_f32_32x32x16_bf16 v[26:41], v[66:69], a[88:91], v[26:41]
    buffer_load_dwordx4 v126, s[28:31], s48 offen offset:3072 sc1 lds
    s_barrier
    ds_read_b64_tr_b16 v[58:59], v5 offset:32768
    v_mfma_f32_32x32x16_bf16 v[26:41], v[70:73], a[120:123], v[26:41]
    ds_read_b64_tr_b16 v[60:61], v5 offset:33280
    ds_read_b64_tr_b16 v[62:63], v5 offset:36864
    ds_read_b64_tr_b16 v[64:65], v5 offset:37376
    v_mul_f32 v147, v124, v121
    s_waitcnt lgkmcnt(4)
    v_mfma_f32_32x32x16_bf16 v[26:41], v[74:77], a[152:155], v[26:41]
    s_sub_u32 s48, s53, s45
    s_and_b32 s48, s48, 3
    s_lshl_b32 s48, s48, 14
    s_add_u32 s48, s48, s46
    s_cmp_eq_u32 s37, 0
    s_cselect_b32 s48, 2146435072, s48
    buffer_load_dword v253, v252, s[28:31], s48 offen sc1
    ds_read_b64_tr_b16 v[66:67], v14 offset:32768
    v_mfma_f32_32x32x16_bf16 v[26:41], v[78:81], a[184:187], v[26:41]
    ds_read_b64_tr_b16 v[68:69], v14 offset:33280
    ds_read_b64_tr_b16 v[70:71], v14 offset:36864
    ds_read_b64_tr_b16 v[72:73], v14 offset:37376
    v_mfma_f32_32x32x16_bf16 v[26:41], v[82:85], a[216:219], v[26:41]
    s_mov_b32 s5, 7372800
    buffer_load_dwordx4 v[200:203], v254, s[28:31], s5 offen offset:0 sc1
    ds_read_b64_tr_b16 v[74:75], v15 offset:32768
    v_mfma_f32_32x32x16_bf16 v[26:41], v[86:89], a[248:251], v[26:41]
    ds_read_b64_tr_b16 v[76:77], v15 offset:33280
    ds_read_b64_tr_b16 v[78:79], v15 offset:36864
    ds_read_b64_tr_b16 v[80:81], v15 offset:37376
    s_waitcnt lgkmcnt(4)
    v_mfma_f32_32x32x16_bf16 v[26:41], v[58:61], a[28:31], v[26:41]
    buffer_load_dwordx4 v[204:207], v254, s[28:31], s5 offen offset:1024 sc1
    ds_read_b64_tr_b16 v[82:83], v16 offset:32768
    v_mfma_f32_32x32x16_bf16 v[26:41], v[62:65], a[60:63], v[26:41]
    ds_read_b64_tr_b16 v[84:85], v16 offset:33280
    ds_read_b64_tr_b16 v[86:87], v16 offset:36864
    ds_read_b64_tr_b16 v[88:89], v16 offset:37376
    v_mfma_f32_32x32x16_bf16 v[26:41], v[66:69], a[92:95], v[26:41]
    buffer_load_dwordx4 v[208:211], v254, s[28:31], s5 offen offset:2048 sc1
    ds_read_b64_tr_b16 a[0:1], v103 offset:32768
    ds_read_b64_tr_b16 a[2:3], v103 offset:33280
    ds_read_b64_tr_b16 a[4:5], v112 offset:32768
    ds_read_b64_tr_b16 a[6:7], v112 offset:33280
    v_mfma_f32_32x32x16_bf16 v[26:41], v[70:73], a[124:127], v[26:41]
    ds_read_b64_tr_b16 a[8:9], v122 offset:32768
    ds_read_b64_tr_b16 a[10:11], v122 offset:33280
    ds_read_b64_tr_b16 a[12:13], v123 offset:32768
    ds_read_b64_tr_b16 a[14:15], v123 offset:33280
    s_waitcnt lgkmcnt(8)
    v_mfma_f32_32x32x16_bf16 v[26:41], v[74:77], a[156:159], v[26:41]
    buffer_load_dwordx4 v[212:215], v254, s[28:31], s5 offen offset:3072 sc1
    ds_read_b64_tr_b16 a[16:17], v103 offset:33792
    ds_read_b64_tr_b16 a[18:19], v103 offset:34304
    ds_read_b64_tr_b16 a[20:21], v112 offset:33792
    ds_read_b64_tr_b16 a[22:23], v112 offset:34304
    v_mfma_f32_32x32x16_bf16 v[26:41], v[78:81], a[188:191], v[26:41]
    ds_read_b64_tr_b16 a[24:25], v122 offset:33792
    ds_read_b64_tr_b16 a[26:27], v122 offset:34304
    ds_read_b64_tr_b16 a[28:29], v123 offset:33792
    ds_read_b64_tr_b16 a[30:31], v123 offset:34304
    v_mfma_f32_32x32x16_bf16 v[26:41], v[82:85], a[220:223], v[26:41]
    s_mov_b32 s5, 7376896
    buffer_load_dwordx4 v[216:219], v254, s[28:31], s5 offen offset:0 sc1
    ds_read_b64_tr_b16 a[32:33], v103 offset:34816
    ds_read_b64_tr_b16 a[34:35], v103 offset:35328
    ds_read_b64_tr_b16 a[36:37], v112 offset:34816
    ds_read_b64_tr_b16 a[38:39], v112 offset:35328
    v_mfma_f32_32x32x16_bf16 v[26:41], v[86:89], a[252:255], v[26:41]
    ds_read_b64_tr_b16 a[40:41], v122 offset:34816
    ds_read_b64_tr_b16 a[42:43], v122 offset:35328
    ds_read_b64_tr_b16 a[44:45], v123 offset:34816
    ds_read_b64_tr_b16 a[46:47], v123 offset:35328
    s_waitcnt lgkmcnt(15)
    v_mfma_f32_16x16x32_bf16 v[232:235], a[0:3], v[168:171], v[232:235]
    s_nop 5
    ds_write_b128 v22, v[34:37] offset:0
    ds_write_b128 v22, v[38:41] offset:1024
    v_mfma_f32_16x16x32_bf16 v[236:239], a[4:7], v[168:171], v[236:239]
    v_pk_fma_f32 v[26:27], v[26:27], v[114:115], v[140:141]
    v_pk_fma_f32 v[28:29], v[28:29], v[116:117], v[142:143]
    ds_read_b64_tr_b16 a[48:49], v103 offset:35840
    ds_read_b64_tr_b16 a[50:51], v103 offset:36352
    v_mfma_f32_16x16x32_bf16 v[240:243], a[8:11], v[168:171], v[240:243]
    v_pk_fma_f32 v[30:31], v[30:31], v[118:119], v[144:145]
    v_pk_fma_f32 v[32:33], v[32:33], v[120:121], v[146:147]
    ds_read_b64_tr_b16 a[52:53], v112 offset:35840
    ds_read_b64_tr_b16 a[54:55], v112 offset:36352
    v_mfma_f32_16x16x32_bf16 v[244:247], a[12:15], v[168:171], v[244:247]
    ds_read_b64_tr_b16 a[56:57], v122 offset:35840
    ds_read_b64_tr_b16 a[58:59], v122 offset:36352
    s_waitcnt lgkmcnt(15)
    v_mfma_f32_16x16x32_bf16 v[232:235], a[16:19], v[172:175], v[232:235]
    ds_read_b64_tr_b16 a[60:61], v123 offset:35840
    ds_read_b64_tr_b16 a[62:63], v123 offset:36352
    v_mfma_f32_16x16x32_bf16 v[236:239], a[20:23], v[172:175], v[236:239]
    ds_read_b64_tr_b16 a[64:65], v103 offset:49152
    ds_read_b64_tr_b16 a[66:67], v103 offset:49664
    s_waitcnt lgkmcnt(10)
    s_barrier
    ds_read_b128 v[90:93], v23 offset:0
    ds_read_b128 v[94:97], v23 offset:1024
    v_mfma_f32_16x16x32_bf16 v[240:243], a[24:27], v[172:175], v[240:243]
    ds_read_b64_tr_b16 a[68:69], v112 offset:49152
    ds_read_b64_tr_b16 a[70:71], v112 offset:49664
    v_mfma_f32_16x16x32_bf16 v[244:247], a[28:31], v[172:175], v[244:247]
    ds_read_b64_tr_b16 a[72:73], v122 offset:49152
    ds_read_b64_tr_b16 a[74:75], v122 offset:49664
    v_mfma_f32_16x16x32_bf16 v[232:235], a[32:35], v[176:179], v[232:235]
    ds_read_b64_tr_b16 a[76:77], v123 offset:49152
    ds_read_b64_tr_b16 a[78:79], v123 offset:49664
    v_mfma_f32_16x16x32_bf16 v[236:239], a[36:39], v[176:179], v[236:239]
    ds_read_b64_tr_b16 a[80:81], v103 offset:50176
    ds_read_b64_tr_b16 a[82:83], v103 offset:50688
    s_waitcnt lgkmcnt(9)
    v_pk_fma_f32 v[26:27], v[90:91], v[114:115], v[26:27]
    v_pk_fma_f32 v[28:29], v[92:93], v[116:117], v[28:29]
    s_waitcnt lgkmcnt(8)
    v_pk_fma_f32 v[30:31], v[94:95], v[118:119], v[30:31]
    v_pk_fma_f32 v[32:33], v[96:97], v[120:121], v[32:33]
    v_cvt_pk_bf16_f32 v98, v26, v27
    v_cvt_pk_bf16_f32 v99, v28, v29
    v_cvt_pk_bf16_f32 v100, v30, v31
    v_cvt_pk_bf16_f32 v101, v32, v33
    s_mov_b32 s47, 7405568
    buffer_store_dwordx4 v[98:101], v25, s[28:31], s47 offen sc1
    v_mfma_f32_16x16x32_bf16 v[240:243], a[40:43], v[176:179], v[240:243]
    buffer_load_dwordx4 v[220:223], v254, s[28:31], s5 offen offset:1024 sc1
    ds_read_b64_tr_b16 a[84:85], v112 offset:50176
    ds_read_b64_tr_b16 a[86:87], v112 offset:50688
    v_mfma_f32_16x16x32_bf16 v[244:247], a[44:47], v[176:179], v[244:247]
    ds_read_b64_tr_b16 a[88:89], v122 offset:50176
    ds_read_b64_tr_b16 a[90:91], v122 offset:50688
    v_mfma_f32_16x16x32_bf16 v[232:235], a[48:51], v[180:183], v[232:235]
    buffer_load_dwordx4 v[224:227], v254, s[28:31], s5 offen offset:2048 sc1
    ds_read_b64_tr_b16 a[92:93], v123 offset:50176
    ds_read_b64_tr_b16 a[94:95], v123 offset:50688
    v_mfma_f32_16x16x32_bf16 v[236:239], a[52:55], v[180:183], v[236:239]
    ds_read_b64_tr_b16 a[96:97], v103 offset:51200
    ds_read_b64_tr_b16 a[98:99], v103 offset:51712
    v_mfma_f32_16x16x32_bf16 v[240:243], a[56:59], v[180:183], v[240:243]
    buffer_load_dwordx4 v[228:231], v254, s[28:31], s5 offen offset:3072 sc1
    ds_read_b64_tr_b16 a[100:101], v112 offset:51200
    ds_read_b64_tr_b16 a[102:103], v112 offset:51712
    v_mfma_f32_16x16x32_bf16 v[244:247], a[60:63], v[180:183], v[244:247]
    ds_read_b64_tr_b16 a[104:105], v122 offset:51200
    ds_read_b64_tr_b16 a[106:107], v122 offset:51712
    v_mfma_f32_16x16x32_bf16 v[232:235], a[64:67], v[184:187], v[232:235]
    s_add_u32 m0, s54, 98304
    s_add_u32 s50, s38, 0
    s_mul_i32 s50, s50, 43
    s_lshr_b32 s50, s50, 7
    s_lshl_b32 s50, s50, 16
    s_add_u32 s50, s50, 65536
    buffer_load_dwordx4 v102, s[20:23], s50 offen  lds
    ds_read_b64_tr_b16 a[108:109], v123 offset:51200
    ds_read_b64_tr_b16 a[110:111], v123 offset:51712
    s_waitcnt lgkmcnt(15)
    v_mfma_f32_16x16x32_bf16 v[236:239], a[68:71], v[184:187], v[236:239]
    v_add_u32 v252, 65536, v252
    s_waitcnt vmcnt(10)
    ds_write_b32 v252, v253
    ds_read_b64_tr_b16 a[112:113], v103 offset:52224
    ds_read_b64_tr_b16 a[114:115], v103 offset:52736
    v_mfma_f32_16x16x32_bf16 v[240:243], a[72:75], v[184:187], v[240:243]
    s_add_u32 m0, s54, 99328
    s_add_u32 s50, s38, 4
    s_mul_i32 s50, s50, 43
    s_lshr_b32 s50, s50, 7
    s_lshl_b32 s50, s50, 16
    s_add_u32 s50, s50, 98304
    buffer_load_dwordx4 v102, s[20:23], s50 offen  lds
    ds_read_b64_tr_b16 a[116:117], v112 offset:52224
    ds_read_b64_tr_b16 a[118:119], v112 offset:52736
    v_mfma_f32_16x16x32_bf16 v[244:247], a[76:79], v[184:187], v[244:247]
    ds_read_b64_tr_b16 a[120:121], v122 offset:52224
    ds_read_b64_tr_b16 a[122:123], v122 offset:52736
    s_waitcnt lgkmcnt(15)
    v_mfma_f32_16x16x32_bf16 v[232:235], a[80:83], v[188:191], v[232:235]
    s_add_u32 m0, s54, 100352
    s_add_u32 s50, s38, 8
    s_mul_i32 s50, s50, 43
    s_lshr_b32 s50, s50, 7
    s_lshl_b32 s50, s50, 16
    s_add_u32 s50, s50, 131072
    buffer_load_dwordx4 v102, s[20:23], s50 offen  lds
    ds_read_b64_tr_b16 a[124:125], v123 offset:52224
    ds_read_b64_tr_b16 a[126:127], v123 offset:52736
    s_waitcnt lgkmcnt(8)
    s_barrier
    v_mfma_f32_16x16x32_bf16 v[236:239], a[84:87], v[188:191], v[236:239]
    ds_read2st64_b32 a[128:129], v248 offset0:0 offset1:1
    ds_read2st64_b32 a[130:131], v248 offset0:2 offset1:3
    v_mfma_f32_16x16x32_bf16 v[240:243], a[88:91], v[188:191], v[240:243]
    s_add_u32 m0, s54, 101376
    s_add_u32 s50, s38, 12
    s_mul_i32 s50, s50, 43
    s_lshr_b32 s50, s50, 7
    s_lshl_b32 s50, s50, 16
    s_add_u32 s50, s50, 163840
    buffer_load_dwordx4 v102, s[20:23], s50 offen  lds
    ds_read2st64_b32 a[132:133], v249 offset0:0 offset1:1
    ds_read2st64_b32 a[134:135], v249 offset0:2 offset1:3
    v_mfma_f32_16x16x32_bf16 v[244:247], a[92:95], v[188:191], v[244:247]
    ds_read2st64_b32 a[136:137], v250 offset0:0 offset1:1
    ds_read2st64_b32 a[138:139], v250 offset0:2 offset1:3
    v_mfma_f32_16x16x32_bf16 v[232:235], a[96:99], v[192:195], v[232:235]
    s_add_u32 m0, s54, 32768
    s_add_u32 s50, s38, 16
    s_mul_i32 s50, s50, 43
    s_lshr_b32 s50, s50, 7
    s_lshl_b32 s50, s50, 16
    s_add_u32 s50, s50, 196608
    buffer_load_dwordx4 v102, s[20:23], s50 offen  lds
    ds_read2st64_b32 a[140:141], v251 offset0:0 offset1:1
    ds_read2st64_b32 a[142:143], v251 offset0:2 offset1:3
    v_mfma_f32_16x16x32_bf16 v[236:239], a[100:103], v[192:195], v[236:239]
    ds_read2st64_b32 a[144:145], v248 offset0:16 offset1:17
    ds_read2st64_b32 a[146:147], v248 offset0:18 offset1:19
    v_mfma_f32_16x16x32_bf16 v[240:243], a[104:107], v[192:195], v[240:243]
    s_add_u32 m0, s54, 33792
    s_mov_b32 s50, 688128
    buffer_load_dwordx4 v102, s[20:23], s50 offen  lds
    ds_read2st64_b32 a[148:149], v249 offset0:16 offset1:17
    ds_read2st64_b32 a[150:151], v249 offset0:18 offset1:19
    v_mfma_f32_16x16x32_bf16 v[244:247], a[108:111], v[192:195], v[244:247]
    ds_read2st64_b32 a[152:153], v250 offset0:16 offset1:17
    ds_read2st64_b32 a[154:155], v250 offset0:18 offset1:19
    s_waitcnt lgkmcnt(15)
    v_mfma_f32_16x16x32_bf16 v[232:235], a[112:115], v[196:199], v[232:235]
    ds_read2st64_b32 a[156:157], v251 offset0:16 offset1:17
    ds_read2st64_b32 a[158:159], v251 offset0:18 offset1:19
    v_mfma_f32_16x16x32_bf16 v[236:239], a[116:119], v[196:199], v[236:239]
    ds_read2st64_b32 a[160:161], v248 offset0:32 offset1:33
    ds_read2st64_b32 a[162:163], v248 offset0:34 offset1:35
    v_mfma_f32_16x16x32_bf16 v[240:243], a[120:123], v[196:199], v[240:243]
    ds_read2st64_b32 a[164:165], v249 offset0:32 offset1:33
    ds_read2st64_b32 a[166:167], v249 offset0:34 offset1:35
    s_waitcnt lgkmcnt(15)
    v_mfma_f32_16x16x32_bf16 v[244:247], a[124:127], v[196:199], v[244:247]
    ds_read2st64_b32 a[168:169], v250 offset0:32 offset1:33
    ds_read2st64_b32 a[170:171], v250 offset0:34 offset1:35
    v_mfma_f32_16x16x32_bf16 v[232:235], a[128:131], v[152:155], v[232:235]
    ds_read2st64_b32 a[172:173], v251 offset0:32 offset1:33
    ds_read2st64_b32 a[174:175], v251 offset0:34 offset1:35
    v_mfma_f32_16x16x32_bf16 v[236:239], a[132:135], v[152:155], v[236:239]
    ds_read2st64_b32 a[176:177], v248 offset0:48 offset1:49
    ds_read2st64_b32 a[178:179], v248 offset0:50 offset1:51
    s_waitcnt lgkmcnt(15)
    v_mfma_f32_16x16x32_bf16 v[240:243], a[136:139], v[152:155], v[240:243]
    ds_read2st64_b32 a[180:181], v249 offset0:48 offset1:49
    ds_read2st64_b32 a[182:183], v249 offset0:50 offset1:51
    v_mfma_f32_16x16x32_bf16 v[244:247], a[140:143], v[152:155], v[244:247]
    ds_read2st64_b32 a[184:185], v250 offset0:48 offset1:49
    ds_read2st64_b32 a[186:187], v250 offset0:50 offset1:51
    v_mfma_f32_16x16x32_bf16 v[232:235], a[144:147], v[156:159], v[232:235]
    ds_read2st64_b32 a[188:189], v251 offset0:48 offset1:49
    ds_read2st64_b32 a[190:191], v251 offset0:50 offset1:51
    s_waitcnt lgkmcnt(15)
    v_mfma_f32_16x16x32_bf16 v[236:239], a[148:151], v[156:159], v[236:239]
    ds_read_b64_tr_b16 a[192:193], v148 offset:16384
    ds_read_b64_tr_b16 a[194:195], v148 offset:16896
    v_mfma_f32_16x16x32_bf16 v[240:243], a[152:155], v[156:159], v[240:243]
    ds_read_b64_tr_b16 a[196:197], v149 offset:16384
    ds_read_b64_tr_b16 a[198:199], v149 offset:16896
    v_mfma_f32_16x16x32_bf16 v[244:247], a[156:159], v[156:159], v[244:247]
    ds_read_b64_tr_b16 a[200:201], v150 offset:16384
    ds_read_b64_tr_b16 a[202:203], v150 offset:16896
    s_waitcnt lgkmcnt(15)
    v_mfma_f32_16x16x32_bf16 v[232:235], a[160:163], v[160:163], v[232:235]
    ds_read_b64_tr_b16 a[204:205], v151 offset:16384
    ds_read_b64_tr_b16 a[206:207], v151 offset:16896
    v_mfma_f32_16x16x32_bf16 v[236:239], a[164:167], v[160:163], v[236:239]
    ds_read_b64_tr_b16 a[208:209], v148 offset:17408
    ds_read_b64_tr_b16 a[210:211], v148 offset:17920
    v_mfma_f32_16x16x32_bf16 v[240:243], a[168:171], v[160:163], v[240:243]
    ds_read_b64_tr_b16 a[212:213], v149 offset:17408
    ds_read_b64_tr_b16 a[214:215], v149 offset:17920
    s_waitcnt lgkmcnt(15)
    v_mfma_f32_16x16x32_bf16 v[244:247], a[172:175], v[160:163], v[244:247]
    ds_read_b64_tr_b16 a[216:217], v150 offset:17408
    ds_read_b64_tr_b16 a[218:219], v150 offset:17920
    v_mfma_f32_16x16x32_bf16 v[232:235], a[176:179], v[164:167], v[232:235]
    ds_read_b64_tr_b16 a[220:221], v151 offset:17408
    ds_read_b64_tr_b16 a[222:223], v151 offset:17920
    v_mfma_f32_16x16x32_bf16 v[236:239], a[180:183], v[164:167], v[236:239]
    ds_read_b64_tr_b16 a[224:225], v148 offset:18432
    ds_read_b64_tr_b16 a[226:227], v148 offset:18944
    s_waitcnt lgkmcnt(15)
    v_mfma_f32_16x16x32_bf16 v[240:243], a[184:187], v[164:167], v[240:243]
    ds_read_b64_tr_b16 a[228:229], v149 offset:18432
    ds_read_b64_tr_b16 a[230:231], v149 offset:18944
    v_mfma_f32_16x16x32_bf16 v[244:247], a[188:191], v[164:167], v[244:247]
    ds_read_b64_tr_b16 a[232:233], v150 offset:18432
    ds_read_b64_tr_b16 a[234:235], v150 offset:18944
    s_mov_b32 s52, 0
    s_waitcnt vmcnt(6)
L_rh1:
    v_max3_i32 v6, v200, v204, v208
    v_max3_i32 v6, v6, v212, v216
    v_max3_i32 v6, v6, v220, v224
    v_max_i32 v6, v6, v228
    v_cmp_eq_u32 vcc, 2139193217, v6
    s_cbranch_vccnz L_sh1
L_bh1:
    v_mfma_f32_16x16x32_bf16 v[232:235], a[192:195], v[200:203], v[232:235]
    s_mov_b32 s5, 7405568
    buffer_load_dwordx4 v[42:45], v254, s[28:31], s5 offen offset:0 sc1
    ds_read_b64_tr_b16 a[236:237], v151 offset:18432
    ds_read_b64_tr_b16 a[238:239], v151 offset:18944
    s_waitcnt lgkmcnt(15)
    v_mfma_f32_16x16x32_bf16 v[236:239], a[196:199], v[200:203], v[236:239]
    buffer_load_dwordx4 v[46:49], v254, s[28:31], s5 offen offset:1024 sc1
    ds_read_b64_tr_b16 a[240:241], v148 offset:19456
    ds_read_b64_tr_b16 a[242:243], v148 offset:19968
    v_mfma_f32_16x16x32_bf16 v[240:243], a[200:203], v[200:203], v[240:243]
    buffer_load_dwordx4 v[50:53], v254, s[28:31], s5 offen offset:2048 sc1
    ds_read_b64_tr_b16 a[244:245], v149 offset:19456
    ds_read_b64_tr_b16 a[246:247], v149 offset:19968
    v_mfma_f32_16x16x32_bf16 v[244:247], a[204:207], v[200:203], v[244:247]
    buffer_load_dwordx4 v[54:57], v254, s[28:31], s5 offen offset:3072 sc1
    ds_read_b64_tr_b16 a[248:249], v150 offset:19456
    ds_read_b64_tr_b16 a[250:251], v150 offset:19968
    s_waitcnt lgkmcnt(15)
    v_mfma_f32_16x16x32_bf16 v[232:235], a[208:211], v[204:207], v[232:235]
    s_mov_b32 s5, 7409664
    buffer_load_dwordx4 v[58:61], v254, s[28:31], s5 offen offset:0 sc1
    ds_read_b64_tr_b16 a[252:253], v151 offset:19456
    ds_read_b64_tr_b16 a[254:255], v151 offset:19968
    v_mfma_f32_16x16x32_bf16 v[236:239], a[212:215], v[204:207], v[236:239]
    buffer_load_dwordx4 v[62:65], v255, s[28:31], s5 offen offset:1024 sc1
    ds_read_b64_tr_b16 a[0:1], v148 offset:49152
    ds_read_b64_tr_b16 a[2:3], v148 offset:49664
    v_mfma_f32_16x16x32_bf16 v[240:243], a[216:219], v[204:207], v[240:243]
    ds_read_b64_tr_b16 a[4:5], v149 offset:49152
    ds_read_b64_tr_b16 a[6:7], v149 offset:49664
    s_waitcnt lgkmcnt(15)
    v_mfma_f32_16x16x32_bf16 v[244:247], a[220:223], v[204:207], v[244:247]
    ds_read_b64_tr_b16 a[8:9], v150 offset:49152
    ds_read_b64_tr_b16 a[10:11], v150 offset:49664
    v_mfma_f32_16x16x32_bf16 v[232:235], a[224:227], v[208:211], v[232:235]
    ds_read_b64_tr_b16 a[12:13], v151 offset:49152
    ds_read_b64_tr_b16 a[14:15], v151 offset:49664
    v_mfma_f32_16x16x32_bf16 v[236:239], a[228:231], v[208:211], v[236:239]
    ds_read_b64_tr_b16 a[16:17], v148 offset:50176
    ds_read_b64_tr_b16 a[18:19], v148 offset:50688
    s_waitcnt lgkmcnt(15)
    v_mfma_f32_16x16x32_bf16 v[240:243], a[232:235], v[208:211], v[240:243]
    ds_read_b64_tr_b16 a[20:21], v149 offset:50176
    ds_read_b64_tr_b16 a[22:23], v149 offset:50688
    v_mfma_f32_16x16x32_bf16 v[244:247], a[236:239], v[208:211], v[244:247]
    ds_read_b64_tr_b16 a[24:25], v150 offset:50176
    ds_read_b64_tr_b16 a[26:27], v150 offset:50688
    v_mfma_f32_16x16x32_bf16 v[232:235], a[240:243], v[212:215], v[232:235]
    ds_read_b64_tr_b16 a[28:29], v151 offset:50176
    ds_read_b64_tr_b16 a[30:31], v151 offset:50688
    s_waitcnt lgkmcnt(15)
    v_mfma_f32_16x16x32_bf16 v[236:239], a[244:247], v[212:215], v[236:239]
    ds_read_b64_tr_b16 a[32:33], v148 offset:51200
    ds_read_b64_tr_b16 a[34:35], v148 offset:51712
    v_mfma_f32_16x16x32_bf16 v[240:243], a[248:251], v[212:215], v[240:243]
    ds_read_b64_tr_b16 a[36:37], v149 offset:51200
    ds_read_b64_tr_b16 a[38:39], v149 offset:51712
    v_mfma_f32_16x16x32_bf16 v[244:247], a[252:255], v[212:215], v[244:247]
    ds_read_b64_tr_b16 a[40:41], v150 offset:51200
    ds_read_b64_tr_b16 a[42:43], v150 offset:51712
    s_waitcnt vmcnt(6)
    s_barrier
    s_waitcnt lgkmcnt(15)
    v_mfma_f32_16x16x32_bf16 v[232:235], a[0:3], v[216:219], v[232:235]
    ds_read_b64_tr_b16 a[44:45], v151 offset:51200
    ds_read_b64_tr_b16 a[46:47], v151 offset:51712
    v_mfma_f32_16x16x32_bf16 v[236:239], a[4:7], v[216:219], v[236:239]
    ds_read_b64_tr_b16 a[48:49], v148 offset:52224
    ds_read_b64_tr_b16 a[50:51], v148 offset:52736
    v_mfma_f32_16x16x32_bf16 v[240:243], a[8:11], v[216:219], v[240:243]
    ds_read_b64_tr_b16 a[52:53], v149 offset:52224
    ds_read_b64_tr_b16 a[54:55], v149 offset:52736
    s_waitcnt lgkmcnt(15)
    v_mfma_f32_16x16x32_bf16 v[244:247], a[12:15], v[216:219], v[244:247]
    ds_read_b64_tr_b16 a[56:57], v150 offset:52224
    ds_read_b64_tr_b16 a[58:59], v150 offset:52736
    v_mfma_f32_16x16x32_bf16 v[232:235], a[16:19], v[220:223], v[232:235]
    ds_read_b64_tr_b16 a[60:61], v151 offset:52224
    ds_read_b64_tr_b16 a[62:63], v151 offset:52736
    v_mfma_f32_16x16x32_bf16 v[236:239], a[20:23], v[220:223], v[236:239]
    ds_read_b64_tr_b16 a[64:65], v103 offset:0
    ds_read_b64_tr_b16 a[66:67], v103 offset:512
    s_waitcnt lgkmcnt(15)
    v_mfma_f32_16x16x32_bf16 v[240:243], a[24:27], v[220:223], v[240:243]
    ds_read_b64_tr_b16 a[68:69], v112 offset:0
    ds_read_b64_tr_b16 a[70:71], v112 offset:512
    v_mfma_f32_16x16x32_bf16 v[244:247], a[28:31], v[220:223], v[244:247]
    ds_read_b64_tr_b16 a[72:73], v122 offset:0
    ds_read_b64_tr_b16 a[74:75], v122 offset:512
    v_mfma_f32_16x16x32_bf16 v[232:235], a[32:35], v[224:227], v[232:235]
    ds_read_b64_tr_b16 a[76:77], v123 offset:0
    ds_read_b64_tr_b16 a[78:79], v123 offset:512
    s_waitcnt lgkmcnt(15)
    v_mfma_f32_16x16x32_bf16 v[236:239], a[36:39], v[224:227], v[236:239]
    ds_read_b64_tr_b16 a[80:81], v103 offset:1024
    ds_read_b64_tr_b16 a[82:83], v103 offset:1536
    v_mfma_f32_16x16x32_bf16 v[240:243], a[40:43], v[224:227], v[240:243]
    ds_read_b64_tr_b16 a[84:85], v112 offset:1024
    ds_read_b64_tr_b16 a[86:87], v112 offset:1536
    v_mfma_f32_16x16x32_bf16 v[244:247], a[44:47], v[224:227], v[244:247]
    ds_read_b64_tr_b16 a[88:89], v122 offset:1024
    ds_read_b64_tr_b16 a[90:91], v122 offset:1536
    s_waitcnt lgkmcnt(15)
    v_mfma_f32_16x16x32_bf16 v[232:235], a[48:51], v[228:231], v[232:235]
    ds_read_b64_tr_b16 a[92:93], v123 offset:1024
    ds_read_b64_tr_b16 a[94:95], v123 offset:1536
    v_mfma_f32_16x16x32_bf16 v[236:239], a[52:55], v[228:231], v[236:239]
    ds_read_b64_tr_b16 a[96:97], v103 offset:2048
    ds_read_b64_tr_b16 a[98:99], v103 offset:2560
    v_mfma_f32_16x16x32_bf16 v[240:243], a[56:59], v[228:231], v[240:243]
    ds_read_b64_tr_b16 a[100:101], v112 offset:2048
    ds_read_b64_tr_b16 a[102:103], v112 offset:2560
    s_waitcnt lgkmcnt(15)
    v_mfma_f32_16x16x32_bf16 v[244:247], a[60:63], v[228:231], v[244:247]
    ds_read_b64_tr_b16 a[104:105], v122 offset:2048
    ds_read_b64_tr_b16 a[106:107], v122 offset:2560
    s_mov_b32 s52, 0
    s_waitcnt vmcnt(0)
L_rh2:
    v_max3_i32 v6, v42, v46, v50
    v_max3_i32 v6, v6, v54, v58
    v_max_i32 v6, v6, v62
    v_cmp_eq_u32 vcc, 2139193217, v6
    s_cbranch_vccnz L_sh2
L_bh2:
    v_mfma_f32_16x16x32_bf16 v[232:235], a[64:67], v[42:45], v[232:235]
    ds_read_b64_tr_b16 a[108:109], v123 offset:2048
    ds_read_b64_tr_b16 a[110:111], v123 offset:2560
    v_mfma_f32_16x16x32_bf16 v[236:239], a[68:71], v[42:45], v[236:239]
    ds_read_b64_tr_b16 a[112:113], v103 offset:3072
    ds_read_b64_tr_b16 a[114:115], v103 offset:3584
    s_waitcnt lgkmcnt(15)
    v_mfma_f32_16x16x32_bf16 v[240:243], a[72:75], v[42:45], v[240:243]
    ds_read_b64_tr_b16 a[116:117], v112 offset:3072
    ds_read_b64_tr_b16 a[118:119], v112 offset:3584
    v_mfma_f32_16x16x32_bf16 v[244:247], a[76:79], v[42:45], v[244:247]
    ds_read_b64_tr_b16 a[120:121], v122 offset:3072
    ds_read_b64_tr_b16 a[122:123], v122 offset:3584
    v_mfma_f32_16x16x32_bf16 v[232:235], a[80:83], v[46:49], v[232:235]
    ds_read_b64_tr_b16 a[124:125], v123 offset:3072
    ds_read_b64_tr_b16 a[126:127], v123 offset:3584
    s_waitcnt lgkmcnt(15)
    v_mfma_f32_16x16x32_bf16 v[236:239], a[84:87], v[46:49], v[236:239]
    ds_read_b64_tr_b16 a[128:129], v148 offset:0
    ds_read_b64_tr_b16 a[130:131], v148 offset:512
    v_mfma_f32_16x16x32_bf16 v[240:243], a[88:91], v[46:49], v[240:243]
    ds_read_b64_tr_b16 a[132:133], v149 offset:0
    ds_read_b64_tr_b16 a[134:135], v149 offset:512
    v_mfma_f32_16x16x32_bf16 v[244:247], a[92:95], v[46:49], v[244:247]
    ds_read_b64_tr_b16 a[136:137], v150 offset:0
    ds_read_b64_tr_b16 a[138:139], v150 offset:512
    s_waitcnt lgkmcnt(15)
    v_mfma_f32_16x16x32_bf16 v[232:235], a[96:99], v[50:53], v[232:235]
    v_and_b32 v7, 1, v3
    ds_read_b64_tr_b16 a[140:141], v151 offset:0
    ds_read_b64_tr_b16 a[142:143], v151 offset:512
    v_mfma_f32_16x16x32_bf16 v[236:239], a[100:103], v[50:53], v[236:239]
    v_lshlrev_b32 v7, 5, v7
    ds_read_b64_tr_b16 a[144:145], v148 offset:1024
    ds_read_b64_tr_b16 a[146:147], v148 offset:1536
    v_mfma_f32_16x16x32_bf16 v[240:243], a[104:107], v[50:53], v[240:243]
    v_lshrrev_b32 v8, 1, v3
    ds_read_b64_tr_b16 a[148:149], v149 offset:1024
    ds_read_b64_tr_b16 a[150:151], v149 offset:1536
    s_waitcnt lgkmcnt(15)
    v_mfma_f32_16x16x32_bf16 v[244:247], a[108:111], v[50:53], v[244:247]
    v_lshl_add_u32 v7, v8, 4, v7
    ds_read_b64_tr_b16 a[152:153], v150 offset:1024
    ds_read_b64_tr_b16 a[154:155], v150 offset:1536
    v_mfma_f32_16x16x32_bf16 v[232:235], a[112:115], v[54:57], v[232:235]
    s_lshl_b32 s47, s40, 10
    ds_read_b64_tr_b16 a[156:157], v151 offset:1024
    ds_read_b64_tr_b16 a[158:159], v151 offset:1536
    v_mfma_f32_16x16x32_bf16 v[236:239], a[116:119], v[54:57], v[236:239]
    s_add_u32 s47, s47, s55
    s_waitcnt lgkmcnt(15)
    v_mfma_f32_16x16x32_bf16 v[240:243], a[120:123], v[54:57], v[240:243]
    s_lshl_b32 s47, s47, 3
    v_mfma_f32_16x16x32_bf16 v[244:247], a[124:127], v[54:57], v[244:247]
    s_add_u32 s47, s47, s37
    s_waitcnt lgkmcnt(14)
    v_mfma_f32_16x16x32_bf16 v[232:235], a[128:131], v[58:61], v[232:235]
    s_lshl_b32 s47, s47, 7
    s_waitcnt lgkmcnt(12)
    v_mfma_f32_16x16x32_bf16 v[236:239], a[132:135], v[58:61], v[236:239]
    v_mul_u32_u24 v8, 0x10008, v2
    s_waitcnt lgkmcnt(10)
    v_mfma_f32_16x16x32_bf16 v[240:243], a[136:139], v[58:61], v[240:243]
    v_and_b32 v8, 0x70040, v8
    s_waitcnt lgkmcnt(8)
    v_mfma_f32_16x16x32_bf16 v[244:247], a[140:143], v[58:61], v[244:247]
    s_mov_b32 s48, 524288
    s_waitcnt lgkmcnt(6)
    v_mfma_f32_16x16x32_bf16 v[232:235], a[144:147], v[62:65], v[232:235]
    v_add3_u32 v5, v8, v7, s47
    s_waitcnt lgkmcnt(4)
    v_mfma_f32_16x16x32_bf16 v[236:239], a[148:151], v[62:65], v[236:239]
    s_waitcnt lgkmcnt(2)
    v_mfma_f32_16x16x32_bf16 v[240:243], a[152:155], v[62:65], v[240:243]
    s_waitcnt lgkmcnt(0)
    v_mfma_f32_16x16x32_bf16 v[244:247], a[156:159], v[62:65], v[244:247]
    s_nop 0
    v_cvt_pk_bf16_f32 v66, v232, v233
    v_cvt_pk_bf16_f32 v67, v234, v235
    s_nop 0
    v_cvt_pk_bf16_f32 v68, v236, v237
    v_cvt_pk_bf16_f32 v69, v238, v239
    v_cvt_pk_bf16_f32 v70, v240, v241
    v_cvt_pk_bf16_f32 v71, v242, v243
    v_cvt_pk_bf16_f32 v72, v244, v245
    v_cvt_pk_bf16_f32 v73, v246, v247
    v_permlane16_swap_b32 v66, v68
    v_permlane16_swap_b32 v67, v69
    v_mov_b32 v232, v66
    v_mov_b32 v233, v67
    v_mov_b32 v234, v68
    v_mov_b32 v235, v69
    v_permlane16_swap_b32 v70, v72
    v_permlane16_swap_b32 v71, v73
    s_nop 1
    v_mov_b32_dpp v232, v70 row_ror:8 row_mask:0xf bank_mask:0xc
    v_mov_b32_dpp v233, v71 row_ror:8 row_mask:0xf bank_mask:0xc
    v_mov_b32_dpp v234, v72 row_ror:8 row_mask:0xf bank_mask:0xc
    v_mov_b32_dpp v235, v73 row_ror:8 row_mask:0xf bank_mask:0xc
    buffer_store_dwordx4 v[232:235], v5, s[24:27], 0 offen
    v_mov_b32_dpp v70, v66 row_ror:8 row_mask:0xf bank_mask:0x3
    v_mov_b32_dpp v71, v67 row_ror:8 row_mask:0xf bank_mask:0x3
    v_mov_b32_dpp v72, v68 row_ror:8 row_mask:0xf bank_mask:0x3
    v_mov_b32_dpp v73, v69 row_ror:8 row_mask:0xf bank_mask:0x3
    buffer_store_dwordx4 v[70:73], v5, s[24:27], s48 offen
L_end:
    s_endpgm
L_s1:
    s_add_u32 s52, s52, 1
    s_cmp_ge_u32 s52, 20000
    s_cbranch_scc1 L_b1
    buffer_load_dwordx4 a[240:243], v4, s[28:31], s49 offen offset:0 sc1
    buffer_load_dwordx4 a[244:247], v4, s[28:31], s49 offen offset:1024 sc1
    buffer_load_dwordx4 a[248:251], v4, s[28:31], s49 offen offset:2048 sc1
    buffer_load_dwordx4 a[252:255], v4, s[28:31], s49 offen offset:3072 sc1
    s_waitcnt vmcnt(0)
    s_branch L_r1
L_ss2:
    s_mov_b32 s52, 0
L_ls2:
    buffer_load_dword v127, v126, s[28:31], s49 offen sc1
    s_waitcnt vmcnt(0)
    v_cmp_ne_u32 vcc, s43, v127
    s_cbranch_vccz L_bs2
    s_add_u32 s52, s52, 1
    s_cmp_lt_u32 s52, 20000
    s_cbranch_scc1 L_ls2
    s_branch L_bs2
L_sh0:
    s_add_u32 s52, s52, 1
    s_cmp_ge_u32 s52, 20000
    s_cbranch_scc1 L_bh0
    s_mov_b32 s50, 7340032
    buffer_load_dwordx4 v[168:171], v254, s[28:31], s50 offen offset:0 sc1
    buffer_load_dwordx4 v[172:175], v254, s[28:31], s50 offen offset:1024 sc1
    buffer_load_dwordx4 v[176:179], v254, s[28:31], s50 offen offset:2048 sc1
    buffer_load_dwordx4 v[180:183], v254, s[28:31], s50 offen offset:3072 sc1
    s_mov_b32 s50, 7344128
    buffer_load_dwordx4 v[184:187], v254, s[28:31], s50 offen offset:0 sc1
    buffer_load_dwordx4 v[188:191], v254, s[28:31], s50 offen offset:1024 sc1
    buffer_load_dwordx4 v[192:195], v254, s[28:31], s50 offen offset:2048 sc1
    buffer_load_dwordx4 v[196:199], v254, s[28:31], s50 offen offset:3072 sc1
    s_waitcnt vmcnt(0)
    s_branch L_rh0
L_sh1:
    s_add_u32 s52, s52, 1
    s_cmp_ge_u32 s52, 20000
    s_cbranch_scc1 L_bh1
    s_mov_b32 s50, 7372800
    buffer_load_dwordx4 v[200:203], v254, s[28:31], s50 offen offset:0 sc1
    buffer_load_dwordx4 v[204:207], v254, s[28:31], s50 offen offset:1024 sc1
    buffer_load_dwordx4 v[208:211], v254, s[28:31], s50 offen offset:2048 sc1
    buffer_load_dwordx4 v[212:215], v254, s[28:31], s50 offen offset:3072 sc1
    s_mov_b32 s50, 7376896
    buffer_load_dwordx4 v[216:219], v254, s[28:31], s50 offen offset:0 sc1
    buffer_load_dwordx4 v[220:223], v254, s[28:31], s50 offen offset:1024 sc1
    buffer_load_dwordx4 v[224:227], v254, s[28:31], s50 offen offset:2048 sc1
    buffer_load_dwordx4 v[228:231], v254, s[28:31], s50 offen offset:3072 sc1
    s_waitcnt vmcnt(0)
    s_branch L_rh1
L_sh2:
    s_add_u32 s52, s52, 1
    s_cmp_ge_u32 s52, 20000
    s_cbranch_scc1 L_bh2
    s_mov_b32 s50, 7405568
    buffer_load_dwordx4 v[42:45], v254, s[28:31], s50 offen offset:0 sc1
    buffer_load_dwordx4 v[46:49], v254, s[28:31], s50 offen offset:1024 sc1
    buffer_load_dwordx4 v[50:53], v254, s[28:31], s50 offen offset:2048 sc1
    buffer_load_dwordx4 v[54:57], v254, s[28:31], s50 offen offset:3072 sc1
    s_mov_b32 s50, 7409664
    buffer_load_dwordx4 v[58:61], v254, s[28:31], s50 offen offset:0 sc1
    buffer_load_dwordx4 v[62:65], v255, s[28:31], s50 offen offset:1024 sc1
    s_waitcnt vmcnt(0)
    s_branch L_rh2
.section .rodata,"a"
.p2align 6
.amdhsa_kernel parallel_sum__spectral_fnet__mixer_gmlp__prompt_kernel
  .amdhsa_next_free_vgpr 512
  .amdhsa_next_free_sgpr 102
  .amdhsa_accum_offset 256
  .amdhsa_group_segment_fixed_size 0
  .amdhsa_kernarg_size 104
  .amdhsa_user_sgpr_count 2
  .amdhsa_user_sgpr_kernarg_segment_ptr 1
  .amdhsa_system_sgpr_workgroup_id_x 1
.end_amdhsa_kernel
```
